```python
import torch

def _softmax(x, axis=-1):
    return torch.softmax(x, dim=axis)

def _gelu(x):
    return torch.nn.functional.gelu(x, approximate='tanh')

def _silu(x):
    return torch.nn.functional.silu(x)

def _sigmoid(x):
    return torch.sigmoid(x)

def _layernorm(x, axis=-1, eps=1e-05):
    m = x.mean(dim=axis, keepdim=True)
    v = x.var(dim=axis, keepdim=True, unbiased=False)
    return (x - m) / torch.sqrt(v + eps)

def _scatter_add(tgt, idx, src, axis=0):
    return tgt.clone().index_add_(axis, idx, src)

def _segment_sum(src, seg, n):
    out = torch.zeros((n,) + src.shape[1:], dtype=src.dtype)
    return out.index_add_(0, seg, src)

def _pad(x, pw):
    flat = tuple((v for pair in reversed(pw) for v in pair))
    return torch.nn.functional.pad(x, flat)
kernel_name = 'adaLN_cond__gqa_block_cached__dense_activation_relu__decode'

def setup_inputs():

    _w = lambda a: (lambda t: t.to(torch.bfloat16) if t.is_floating_point() else t)(torch.as_tensor(a))

    def _A_setup():
        B, Sq, D = (1, 1, 576)
        Hq, Hkv, Sk, Dh = (32, 16, 65536, 128)
        assert Hq % Hkv == 0, (Hq, Hkv)
        return {'x': _w((lambda *s: torch.randn(*s, dtype=torch.bfloat16) * 0.1)(B, Sq, D)), 'k_cache': _w((lambda *s: torch.randn(*s, dtype=torch.bfloat16) * 0.8)(B, Hkv, Sk, Dh)), 'v_cache': _w((lambda *s: torch.randn(*s, dtype=torch.bfloat16) * 0.8)(B, Hkv, Sk, Dh)), 'wq': _w((lambda *s: torch.randn(*s, dtype=torch.bfloat16) * 0.8)(D, Hq * Dh) * D ** (-0.5)), 'wo': _w((lambda *s: torch.randn(*s, dtype=torch.bfloat16) * 0.8)(Hq * Dh, D) * (Hq * Dh) ** (-0.5))}
    _A_in = _A_setup()

    def _B_setup():
        B, S, D, Dff = (1, 1, 576, 4608)
        return {'x': _w((lambda *s: torch.randn(*s, dtype=torch.bfloat16) * 0.1)(B, S, D)), 'w1': _w((lambda *s: torch.randn(*s, dtype=torch.bfloat16) * 0.1)(D, Dff)), 'w2': _w((lambda *s: torch.randn(*s, dtype=torch.bfloat16) * 0.1)(Dff, D))}
    _B_in = _B_setup()
    return {'A_x': _A_in['x'], 'A_k_cache': _A_in['k_cache'], 'A_v_cache': _A_in['v_cache'], 'A_wq': _A_in['wq'], 'A_wo': _A_in['wo'], 'B_x': _B_in['x'], 'B_w1': _B_in['w1'], 'B_w2': _B_in['w2'], 'c': _w((lambda *s: torch.randn(*s, dtype=torch.bfloat16) * 0.4)(1, 576) * 8.0), 'w_mod': _w((lambda *s: torch.randn(*s, dtype=torch.bfloat16) * 0.4)(576, 6 * 576) * 576 ** (-0.5) * 8.0)}

def reference(A_x, A_k_cache, A_v_cache, A_wq, A_wo, B_x, B_w1, B_w2, c, w_mod):

    def _A_ref(x, k_cache, v_cache, wq, wo):
        B, Sq, D = x.shape
        Hq, Dh = (32, 128)
        Hkv = k_cache.shape[1]
        rep = Hq // Hkv
        q = (lambda x, *d: x.permute(*d))((x @ wq).reshape(B, Sq, Hq, Dh), 0, 2, 1, 3)
        k = (lambda x, n, axis: torch.repeat_interleave(x, n, dim=axis))(k_cache, rep, axis=1)
        v = (lambda x, n, axis: torch.repeat_interleave(x, n, dim=axis))(v_cache, rep, axis=1)
        scores = torch.einsum('bhqd,bhkd->bhqk', q, k) * Dh ** (-0.5)
        p = _softmax(scores, axis=-1)
        o = torch.einsum('bhqk,bhkd->bhqd', p, v)
        return (lambda x, *d: x.permute(*d))(o, 0, 2, 1, 3).reshape(B, Sq, Hq * Dh) @ wo

    def _B_ref(x, w1, w2):
        h = torch.einsum('bsd,df->bsf', x, w1)
        zero = torch.zeros_like(h)
        h = torch.maximum(h, zero)
        return torch.einsum('bsf,fd->bsd', h, w2)
    x = A_x
    mod = (_silu(c) @ w_mod).reshape(c.shape[0], 6, 1, -1)
    sa, ca, ga, sb, cb, gb = (mod[:, 0].clone(), mod[:, 1].clone(), mod[:, 2].clone(), mod[:, 3].clone(), mod[:, 4].clone(), mod[:, 5].clone())
    h = _layernorm(x, axis=-1) * (1 + ca) + sa
    x = x + ga * _A_ref(h, A_k_cache, A_v_cache, A_wq, A_wo)
    h = _layernorm(x, axis=-1) * (1 + cb) + sb
    x = x + gb * _B_ref(h, B_w1, B_w2)
    return x
```

```asm
; @launch grid=(256,1,1) block=(512,1,1) lds=162304
.amdgcn_target "amdgcn-amd-amdhsa--gfx950"
.text
.globl adaLN_cond__gqa_block_cached__dense_activation_relu__decode_kernel
.p2align 8
.type adaLN_cond__gqa_block_cached__dense_activation_relu__decode_kernel,@function
adaLN_cond__gqa_block_cached__dense_activation_relu__decode_kernel:
    s_cmpk_ge_u32 s2, 256
    s_cbranch_scc1 L_end
    s_load_dwordx2 s[36:37], s[0:1], 8
    s_load_dwordx16 s[4:19], s[0:1], 0
    s_load_dwordx8 s[20:27], s[0:1], 64
    s_load_dwordx2 s[28:29], s[0:1], 96
    v_readfirstlane_b32 s3, v0
    v_and_b32 v0, 63, v0
    s_lshr_b32 s3, s3, 6
    v_lshrrev_b32 v1, 4, v0
    s_and_b32 s97, s2, 7
    s_lshr_b32 s98, s2, 3
    s_cmp_ge_u32 s3, 4
    s_cbranch_scc1 L_helper
    s_lshr_b32 s56, s2, 4
    s_lshl4_add_u32 s49, s97, s56
    s_lshl_b32 s49, s49, 11
    s_xor_b32 s56, s98, s3
    s_and_b32 s56, s56, 1
    s_lshl2_add_u32 s56, s56, s3
    s_or_b32 s48, s49, s56
    s_lshl_b32 s48, s48, 10
    v_and_b32 v2, 3, v0
    v_and_b32 v14, 12, v0
    v_or_b32 v14, v14, v1
    v_lshlrev_b32 v2, 4, v2
    v_lshl_add_u32 v2, v14, 6, v2
    s_lshr_b32 s95, s2, 1
    s_xor_b32 s95, s95, s2
    s_bfe_u32 s95, s95, 0x10004
    s_lshr_b32 s56, s2, 7
    s_lshl1_add_u32 s95, s56, s95
    v_lshl_add_u32 v2, s95, 13, v2
    s_brev_b32 s38, 8
    s_mov_b32 s39, 0x20000
    v_xor_b32 v3, 8192, v2
    s_waitcnt lgkmcnt(0)
    buffer_load_dwordx4 v[64:67], v2, s[36:39], s48 offen nt
    buffer_load_dwordx4 v[68:71], v3, s[36:39], s48 offen nt
    v_xor_b32 v4, 16384, v2
    v_xor_b32 v5, 24576, v2
    buffer_load_dwordx4 v[72:75], v4, s[36:39], s48 offen nt
    buffer_load_dwordx4 v[76:79], v5, s[36:39], s48 offen nt
    s_mov_b32 s49, s48
    s_xor_b32 s48, s48, 32768
    buffer_load_dwordx4 v[80:83], v2, s[36:39], s48 offen nt
    s_memrealtime s[92:93]
    s_mov_b32 s94, 131072
    s_lshl_b32 s95, s95, 13
    s_mov_b32 s40, s8
    s_mov_b32 s41, s9
    s_brev_b32 s42, 8
    s_mov_b32 s43, 0x20000
    s_mov_b32 s32, s28
    s_mov_b32 s33, s29
    s_mov_b32 s34, 2097152
    s_mov_b32 s35, 0x20000
    s_mov_b32 s62, 1069066811
    s_mov_b32 s82, 572662306
    s_mov_b32 s83, 572662306
    s_mov_b32 s84, 1145324612
    s_mov_b32 s85, 1145324612
    s_mov_b32 s86, 2290649224
    s_mov_b32 s87, 2290649224
    v_and_b32 v6, 15, v0
    v_lshlrev_b32 v6, 4, v6
    v_bfe_u32 v14, v0, 4, 2
    v_lshl_add_u32 v6, v14, 8, v6
    v_xor_b32 v6, s95, v6
    v_xor_b32 v7, 8192, v6
    v_xor_b32 v8, 16384, v6
    v_xor_b32 v9, 24576, v6
    s_mul_i32 s56, s3, 16384
    s_add_u32 s56, s56, 6656
    v_lshl_add_u32 v44, v0, 4, s56
    s_sub_u32 m0, s56, 1024
    v_and_b32 v14, 1, v0
    v_lshlrev_b32 v14, 4, v14
    v_mov_b32 v15, 0xffff
    v_lshlrev_b32 v14, v14, v15
    v_bfe_u32 v15, v0, 1, 2
    v_cmp_eq_u32 vcc, 0, v15
    s_nop 1
    v_cndmask_b32 v10, 0, v14, vcc
    v_cmp_eq_u32 vcc, 1, v15
    s_nop 1
    v_cndmask_b32 v11, 0, v14, vcc
    v_cmp_eq_u32 vcc, 2, v15
    s_nop 1
    v_cndmask_b32 v12, 0, v14, vcc
    v_cmp_eq_u32 vcc, 3, v15
    s_nop 1
    v_cndmask_b32 v13, 0, v14, vcc
    v_bfe_u32 v60, v0, 3, 1
    v_lshlrev_b32 v60, 4, v60
    v_lshl_add_u32 v60, v1, 2, v60
    v_and_b32 v14, 3, v0
    v_add_lshl_u32 v60, v60, v14, 4
    v_mov_b32 v24, 0
    v_mov_b32 v25, 0
    v_mov_b32 v26, 0
    v_mov_b32 v27, 0
    v_mov_b32 v63, 0
    v_mov_b32 v61, 4271273625
    v_mul_f32 v62, 3216550459, v61
    s_lshl_b32 s56, s3, 12
    s_add_u32 s56, s56, 145920
    v_lshl_add_u32 v1, v0, 2, s56
    s_sub_u32 s56, s98, 14
    s_cmp_lt_u32 s56, 9
    s_cselect_b64 vcc, -1, 0
    s_cbranch_vccnz L_t2_1
    s_waitcnt vmcnt(4)
L_t2_1:
    buffer_load_dwordx4 v[84:87], v3, s[36:39], s48 offen nt
    s_cbranch_vccnz L_t2_2
    s_waitcnt vmcnt(4)
L_t2_2:
    s_waitcnt vmcnt(5)
    buffer_load_dwordx4 v[88:91], v4, s[36:39], s48 offen nt
    s_cbranch_vccnz L_t2_3
    s_waitcnt vmcnt(4)
L_t2_3:
    s_waitcnt vmcnt(5)
    buffer_load_dwordx4 v[92:95], v5, s[36:39], s48 offen nt
    s_xor_b32 s48, s48, 98304
    s_cbranch_vccnz L_t2_4
    s_waitcnt vmcnt(4)
L_t2_4:
    s_waitcnt vmcnt(5)
    buffer_load_dwordx4 v[96:99], v2, s[36:39], s48 offen nt
    s_cbranch_vccnz L_t2_5
    s_waitcnt vmcnt(4)
L_t2_5:
    s_waitcnt vmcnt(5)
    buffer_load_dwordx4 v[100:103], v3, s[36:39], s48 offen nt
    s_barrier
    s_cbranch_vccnz L_t2_6
    s_waitcnt vmcnt(4)
L_t2_6:
    s_waitcnt vmcnt(5)
    buffer_load_dwordx4 v[104:107], v4, s[36:39], s48 offen nt
    s_cbranch_vccnz L_t2_7
    s_waitcnt vmcnt(4)
L_t2_7:
    s_waitcnt vmcnt(5)
    buffer_load_dwordx4 v[108:111], v5, s[36:39], s48 offen nt
    s_xor_b32 s48, s48, 32768
    s_cbranch_vccnz L_t2_8
    s_waitcnt vmcnt(4)
L_t2_8:
    s_waitcnt vmcnt(5)
    buffer_load_dwordx4 v[112:115], v2, s[36:39], s48 offen nt
    s_cbranch_vccnz L_t2_9
    s_waitcnt vmcnt(4)
L_t2_9:
    s_waitcnt vmcnt(5)
    buffer_load_dwordx4 v[116:119], v3, s[36:39], s48 offen nt
    s_cbranch_vccnz L_t2_10
    s_waitcnt vmcnt(4)
L_t2_10:
    s_waitcnt vmcnt(5)
    buffer_load_dwordx4 v[120:123], v4, s[36:39], s48 offen nt
    s_cbranch_vccnz L_t2_11
    s_waitcnt vmcnt(4)
L_t2_11:
    s_waitcnt vmcnt(5)
    buffer_load_dwordx4 v[124:127], v5, s[36:39], s48 offen nt
    s_xor_b32 s48, s94, s49
    s_sub_u32 s94, s94, 1966080
    s_and_b32 s94, s94, 1966080
    s_cbranch_vccnz L_t2_12
    s_waitcnt vmcnt(4)
L_t2_12:
    s_waitcnt vmcnt(5)
    buffer_load_dwordx4 v[128:131], v2, s[36:39], s48 offen nt
    s_cbranch_vccnz L_t2_13
    s_waitcnt vmcnt(4)
L_t2_13:
    s_waitcnt vmcnt(5)
    buffer_load_dwordx4 v[132:135], v3, s[36:39], s48 offen nt
    s_cbranch_vccnz L_t2_14
    s_waitcnt vmcnt(4)
L_t2_14:
    s_waitcnt vmcnt(5)
    buffer_load_dwordx4 v[136:139], v4, s[36:39], s48 offen nt
    s_cbranch_vccnz L_t2_15
    s_waitcnt vmcnt(4)
L_t2_15:
    s_waitcnt vmcnt(5)
    buffer_load_dwordx4 v[140:143], v5, s[36:39], s48 offen nt
    s_xor_b32 s48, s48, 32768
    s_cbranch_vccnz L_t2_16
    s_waitcnt vmcnt(4)
L_t2_16:
    s_waitcnt vmcnt(5)
    buffer_load_dwordx4 v[144:147], v2, s[36:39], s48 offen nt
    s_cbranch_vccnz L_t2_17
    s_waitcnt vmcnt(4)
L_t2_17:
    s_waitcnt vmcnt(5)
    buffer_load_dwordx4 v[148:151], v3, s[36:39], s48 offen nt
    s_cbranch_vccnz L_t2_18
    s_waitcnt vmcnt(4)
L_t2_18:
    s_waitcnt vmcnt(5)
    buffer_load_dwordx4 v[152:155], v4, s[36:39], s48 offen nt
    s_cbranch_vccnz L_t2_19
    s_waitcnt vmcnt(4)
L_t2_19:
    s_waitcnt vmcnt(5)
    buffer_load_dwordx4 v[156:159], v5, s[36:39], s48 offen nt
    s_xor_b32 s48, s48, 98304
    s_cbranch_vccnz L_t2_20
    s_waitcnt vmcnt(4)
L_t2_20:
    s_waitcnt vmcnt(5)
    buffer_load_dwordx4 v[160:163], v2, s[36:39], s48 offen nt
    s_cbranch_vccnz L_t2_21
    s_waitcnt vmcnt(4)
L_t2_21:
    s_waitcnt vmcnt(5)
    buffer_load_dwordx4 v[164:167], v3, s[36:39], s48 offen nt
    s_cbranch_vccnz L_t2_22
    s_waitcnt vmcnt(4)
L_t2_22:
    s_waitcnt vmcnt(5)
    buffer_load_dwordx4 v[168:171], v4, s[36:39], s48 offen nt
    s_cbranch_vccnz L_t2_23
    s_waitcnt vmcnt(4)
L_t2_23:
    s_waitcnt vmcnt(5)
    buffer_load_dwordx4 v[172:175], v5, s[36:39], s48 offen nt
    s_xor_b32 s48, s48, 32768
    s_cbranch_vccnz L_t2_24
    s_waitcnt vmcnt(4)
L_t2_24:
    s_waitcnt vmcnt(5)
    buffer_load_dwordx4 v[176:179], v2, s[36:39], s48 offen nt
    s_cbranch_vccnz L_t2_25
    s_waitcnt vmcnt(4)
L_t2_25:
    s_waitcnt vmcnt(5)
    buffer_load_dwordx4 v[180:183], v3, s[36:39], s48 offen nt
    s_cbranch_vccnz L_t2_26
    s_waitcnt vmcnt(4)
L_t2_26:
    s_waitcnt vmcnt(5)
    buffer_load_dwordx4 v[184:187], v4, s[36:39], s48 offen nt
    s_cbranch_vccnz L_t2_27
    s_waitcnt vmcnt(4)
L_t2_27:
    s_waitcnt vmcnt(5)
    buffer_load_dwordx4 v[188:191], v5, s[36:39], s48 offen nt
    s_xor_b32 s48, s94, s49
    s_sub_u32 s94, s94, 1966080
    s_and_b32 s94, s94, 1966080
    s_cbranch_vccnz L_t2_28
    s_waitcnt vmcnt(4)
L_t2_28:
    s_waitcnt vmcnt(5)
    buffer_load_dwordx4 v[192:195], v2, s[36:39], s48 offen nt
    s_cbranch_vccnz L_t2_29
    s_waitcnt vmcnt(4)
L_t2_29:
    s_waitcnt vmcnt(5)
    buffer_load_dwordx4 v[196:199], v3, s[36:39], s48 offen nt
    s_cbranch_vccnz L_t2_30
    s_waitcnt vmcnt(4)
L_t2_30:
    s_waitcnt vmcnt(5)
    buffer_load_dwordx4 v[200:203], v4, s[36:39], s48 offen nt
    s_cbranch_vccnz L_t2_31
    s_waitcnt vmcnt(4)
L_t2_31:
    s_waitcnt vmcnt(5)
    buffer_load_dwordx4 v[204:207], v5, s[36:39], s48 offen nt
    s_xor_b32 s48, s48, 32768
    s_cbranch_vccnz L_t2_32
    s_waitcnt vmcnt(4)
L_t2_32:
    s_waitcnt vmcnt(5)
    buffer_load_dwordx4 v[208:211], v2, s[36:39], s48 offen nt
    s_cbranch_vccnz L_t2_33
    s_waitcnt vmcnt(4)
L_t2_33:
    s_waitcnt vmcnt(5)
    buffer_load_dwordx4 v[212:215], v3, s[36:39], s48 offen nt
    s_cbranch_vccnz L_t2_34
    s_waitcnt vmcnt(4)
L_t2_34:
    s_waitcnt vmcnt(5)
    buffer_load_dwordx4 v[216:219], v4, s[36:39], s48 offen nt
    s_cbranch_vccnz L_t2_35
    s_waitcnt vmcnt(4)
L_t2_35:
    s_waitcnt vmcnt(5)
    buffer_load_dwordx4 v[220:223], v5, s[36:39], s48 offen nt
    s_xor_b32 s48, s48, 98304
    s_cbranch_vccnz L_t2_36
    s_waitcnt vmcnt(4)
L_t2_36:
    s_waitcnt vmcnt(5)
    buffer_load_dwordx4 v[224:227], v2, s[36:39], s48 offen nt
    s_cbranch_vccnz L_t2_37
    s_waitcnt vmcnt(4)
L_t2_37:
    s_waitcnt vmcnt(5)
    buffer_load_dwordx4 v[228:231], v3, s[36:39], s48 offen nt
    s_cbranch_vccnz L_t2_38
    s_waitcnt vmcnt(4)
L_t2_38:
    s_waitcnt vmcnt(5)
    buffer_load_dwordx4 v[232:235], v4, s[36:39], s48 offen nt
    s_cbranch_vccnz L_t2_39
    s_waitcnt vmcnt(4)
L_t2_39:
    s_waitcnt vmcnt(5)
    buffer_load_dwordx4 v[236:239], v5, s[36:39], s48 offen nt
    s_xor_b32 s48, s48, 32768
    s_cbranch_vccnz L_t2_40
    s_waitcnt vmcnt(4)
L_t2_40:
    s_waitcnt vmcnt(5)
    buffer_load_dwordx4 v[240:243], v2, s[36:39], s48 offen nt
    s_cbranch_vccnz L_t2_41
    s_waitcnt vmcnt(4)
L_t2_41:
    s_waitcnt vmcnt(5)
    buffer_load_dwordx4 v[244:247], v3, s[36:39], s48 offen nt
    s_cbranch_vccnz L_t2_42
    s_waitcnt vmcnt(4)
L_t2_42:
    s_waitcnt vmcnt(5)
    buffer_load_dwordx4 v[248:251], v4, s[36:39], s48 offen nt
    s_cbranch_vccnz L_t2_43
    s_waitcnt vmcnt(4)
L_t2_43:
    s_waitcnt vmcnt(5)
    buffer_load_dwordx4 v[252:255], v5, s[36:39], s48 offen nt
    s_xor_b32 s48, s94, s49
    s_sub_u32 s94, s94, 1966080
    s_and_b32 s94, s94, 1966080
    s_add_u32 m0, m0, 1024
    s_cbranch_vccnz L_t2_44
    s_waitcnt vmcnt(4)
L_t2_44:
    s_waitcnt vmcnt(5)
    buffer_load_dwordx4 v2, s[36:39], s48 offen nt lds
    s_add_u32 m0, m0, 1024
    s_cbranch_vccnz L_t2_45
    s_waitcnt vmcnt(4)
L_t2_45:
    s_waitcnt vmcnt(5)
    buffer_load_dwordx4 v3, s[36:39], s48 offen nt lds
    s_add_u32 m0, m0, 1024
    s_cbranch_vccnz L_t2_46
    s_waitcnt vmcnt(4)
L_t2_46:
    s_waitcnt vmcnt(5)
    buffer_load_dwordx4 v4, s[36:39], s48 offen nt lds
    s_add_u32 m0, m0, 1024
    s_cbranch_vccnz L_t2_47
    s_waitcnt vmcnt(4)
L_t2_47:
    s_waitcnt vmcnt(5)
    buffer_load_dwordx4 v5, s[36:39], s48 offen nt lds
    s_xor_b32 s48, s48, 32768
    s_add_u32 m0, m0, 1024
    s_cbranch_vccnz L_t2_48
    s_waitcnt vmcnt(4)
L_t2_48:
    s_waitcnt vmcnt(5)
    buffer_load_dwordx4 v2, s[36:39], s48 offen nt lds
    s_add_u32 m0, m0, 1024
    s_cbranch_vccnz L_t2_49
    s_waitcnt vmcnt(4)
L_t2_49:
    s_waitcnt vmcnt(5)
    buffer_load_dwordx4 v3, s[36:39], s48 offen nt lds
    s_add_u32 m0, m0, 1024
    s_cbranch_vccnz L_t2_50
    s_waitcnt vmcnt(4)
L_t2_50:
    s_waitcnt vmcnt(5)
    buffer_load_dwordx4 v4, s[36:39], s48 offen nt lds
    s_add_u32 m0, m0, 1024
    s_cbranch_vccnz L_t2_51
    s_waitcnt vmcnt(4)
L_t2_51:
    s_waitcnt vmcnt(5)
    buffer_load_dwordx4 v5, s[36:39], s48 offen nt lds
    s_xor_b32 s48, s48, 98304
    s_add_u32 m0, m0, 1024
    s_cbranch_vccnz L_t2_52
    s_waitcnt vmcnt(4)
L_t2_52:
    s_waitcnt vmcnt(5)
    buffer_load_dwordx4 v2, s[36:39], s48 offen nt lds
    s_add_u32 m0, m0, 1024
    s_cbranch_vccnz L_t2_53
    s_waitcnt vmcnt(4)
L_t2_53:
    s_waitcnt vmcnt(5)
    buffer_load_dwordx4 v3, s[36:39], s48 offen nt lds
    s_add_u32 m0, m0, 1024
    s_cbranch_vccnz L_t2_54
    s_waitcnt vmcnt(4)
L_t2_54:
    s_waitcnt vmcnt(5)
    buffer_load_dwordx4 v4, s[36:39], s48 offen nt lds
    s_add_u32 m0, m0, 1024
    s_cbranch_vccnz L_t2_55
    s_waitcnt vmcnt(4)
L_t2_55:
    s_waitcnt vmcnt(5)
    buffer_load_dwordx4 v5, s[36:39], s48 offen nt lds
    s_xor_b32 s48, s48, 32768
    s_add_u32 m0, m0, 1024
    s_cbranch_vccnz L_t2_56
    s_waitcnt vmcnt(4)
L_t2_56:
    s_waitcnt vmcnt(5)
    buffer_load_dwordx4 v2, s[36:39], s48 offen nt lds
    s_add_u32 m0, m0, 1024
    s_cbranch_vccnz L_t2_57
    s_waitcnt vmcnt(4)
L_t2_57:
    s_waitcnt vmcnt(5)
    buffer_load_dwordx4 v3, s[36:39], s48 offen nt lds
    s_add_u32 m0, m0, 1024
    s_cbranch_vccnz L_t2_58
    s_waitcnt vmcnt(4)
L_t2_58:
    s_waitcnt vmcnt(5)
    buffer_load_dwordx4 v4, s[36:39], s48 offen nt lds
    s_add_u32 m0, m0, 1024
    s_cbranch_vccnz L_t2_59
    s_waitcnt vmcnt(4)
L_t2_59:
    s_waitcnt vmcnt(5)
    buffer_load_dwordx4 v5, s[36:39], s48 offen nt lds
    s_barrier
    ds_read_b128 v[20:23], v60 offset:1664
    v_and_b32 v14, 4, v0
    v_cmp_eq_u32 vcc, 0, v14
    s_waitcnt lgkmcnt(0)
    s_nop 0
    v_cndmask_b32 v16, 0, v20, vcc
    v_cndmask_b32 v17, 0, v21, vcc
    v_cndmask_b32 v18, 0, v22, vcc
    v_cndmask_b32 v19, 0, v23, vcc
    v_cndmask_b32 v20, v20, 0, vcc
    v_cndmask_b32 v21, v21, 0, vcc
    v_cndmask_b32 v22, v22, 0, vcc
    v_cndmask_b32 v23, v23, 0, vcc
    v_mfma_f32_16x16x32_bf16 v[28:31], v[64:67], v[16:19], 0
    s_xor_b32 s48, s94, s49
    s_sub_u32 s94, s94, 1966080
    s_and_b32 s94, s94, 1966080
    buffer_load_dwordx4 v[64:67], v2, s[36:39], s48 offen nt
    v_mfma_f32_16x16x32_bf16 v[28:31], v[68:71], v[20:23], v[28:31]
    s_waitcnt vmcnt(6)
    buffer_load_dwordx4 v[68:71], v3, s[36:39], s48 offen nt
    v_mfma_f32_16x16x32_bf16 v[32:35], v[72:75], v[16:19], 0
    v_mfma_f32_16x16x32_bf16 v[32:35], v[76:79], v[20:23], v[32:35]
    s_nop 3
    v_mov_b32_dpp v52, v28 quad_perm:[0,0,0,0] row_mask:0xf bank_mask:0xf
    v_add_f32_dpp v52, v29, v52 quad_perm:[1,1,1,1] row_mask:0xf bank_mask:0xf
    v_add_f32_dpp v52, v30, v52 quad_perm:[2,2,2,2] row_mask:0xf bank_mask:0xf
    v_add_f32_dpp v52, v31, v52 quad_perm:[3,3,3,3] row_mask:0xf bank_mask:0xf
    v_cvt_pk_bf16_f32 v52, 0, v52
    v_mul_f32 v52, 1035273459, v52
    v_mfma_f32_16x16x32_bf16 v[28:31], v[80:83], v[16:19], 0
    v_mfma_f32_16x16x32_bf16 v[28:31], v[84:87], v[20:23], v[28:31]
    v_mov_b32_dpp v53, v32 quad_perm:[0,0,0,0] row_mask:0xf bank_mask:0xf
    v_add_f32_dpp v53, v33, v53 quad_perm:[1,1,1,1] row_mask:0xf bank_mask:0xf
    v_add_f32_dpp v53, v34, v53 quad_perm:[2,2,2,2] row_mask:0xf bank_mask:0xf
    v_add_f32_dpp v53, v35, v53 quad_perm:[3,3,3,3] row_mask:0xf bank_mask:0xf
    v_cvt_pk_bf16_f32 v53, 0, v53
    v_mul_f32 v53, 1035273459, v53
    v_cvt_pk_bf16_f32 v46, v52, v53
    v_mfma_f32_16x16x32_bf16 v[32:35], v[88:91], v[16:19], 0
    s_waitcnt vmcnt(6)
    buffer_load_dwordx4 v[72:75], v4, s[36:39], s48 offen nt
    v_mfma_f32_16x16x32_bf16 v[32:35], v[92:95], v[20:23], v[32:35]
    v_mov_b32_dpp v52, v28 quad_perm:[0,0,0,0] row_mask:0xf bank_mask:0xf
    v_add_f32_dpp v52, v29, v52 quad_perm:[1,1,1,1] row_mask:0xf bank_mask:0xf
    v_add_f32_dpp v52, v30, v52 quad_perm:[2,2,2,2] row_mask:0xf bank_mask:0xf
    v_add_f32_dpp v52, v31, v52 quad_perm:[3,3,3,3] row_mask:0xf bank_mask:0xf
    v_cvt_pk_bf16_f32 v52, 0, v52
    v_mul_f32 v52, 1035273459, v52
    v_mfma_f32_16x16x32_bf16 v[28:31], v[96:99], v[16:19], 0
    v_mfma_f32_16x16x32_bf16 v[28:31], v[100:103], v[20:23], v[28:31]
    v_mov_b32_dpp v53, v32 quad_perm:[0,0,0,0] row_mask:0xf bank_mask:0xf
    v_add_f32_dpp v53, v33, v53 quad_perm:[1,1,1,1] row_mask:0xf bank_mask:0xf
    v_add_f32_dpp v53, v34, v53 quad_perm:[2,2,2,2] row_mask:0xf bank_mask:0xf
    v_add_f32_dpp v53, v35, v53 quad_perm:[3,3,3,3] row_mask:0xf bank_mask:0xf
    v_cvt_pk_bf16_f32 v53, 0, v53
    v_mul_f32 v53, 1035273459, v53
    v_cvt_pk_bf16_f32 v47, v52, v53
    v_cndmask_b32 v46, v46, v47, s[82:83]
    v_mfma_f32_16x16x32_bf16 v[32:35], v[104:107], v[16:19], 0
    s_waitcnt vmcnt(6)
    buffer_load_dwordx4 v[76:79], v5, s[36:39], s48 offen nt
    v_mfma_f32_16x16x32_bf16 v[32:35], v[108:111], v[20:23], v[32:35]
    v_mov_b32_dpp v52, v28 quad_perm:[0,0,0,0] row_mask:0xf bank_mask:0xf
    v_add_f32_dpp v52, v29, v52 quad_perm:[1,1,1,1] row_mask:0xf bank_mask:0xf
    v_add_f32_dpp v52, v30, v52 quad_perm:[2,2,2,2] row_mask:0xf bank_mask:0xf
    v_add_f32_dpp v52, v31, v52 quad_perm:[3,3,3,3] row_mask:0xf bank_mask:0xf
    v_cvt_pk_bf16_f32 v52, 0, v52
    v_mul_f32 v52, 1035273459, v52
    v_mfma_f32_16x16x32_bf16 v[28:31], v[112:115], v[16:19], 0
    v_mfma_f32_16x16x32_bf16 v[28:31], v[116:119], v[20:23], v[28:31]
    v_mov_b32_dpp v53, v32 quad_perm:[0,0,0,0] row_mask:0xf bank_mask:0xf
    v_add_f32_dpp v53, v33, v53 quad_perm:[1,1,1,1] row_mask:0xf bank_mask:0xf
    v_add_f32_dpp v53, v34, v53 quad_perm:[2,2,2,2] row_mask:0xf bank_mask:0xf
    v_add_f32_dpp v53, v35, v53 quad_perm:[3,3,3,3] row_mask:0xf bank_mask:0xf
    v_cvt_pk_bf16_f32 v53, 0, v53
    v_mul_f32 v53, 1035273459, v53
    v_cvt_pk_bf16_f32 v47, v52, v53
    v_cndmask_b32 v46, v46, v47, s[84:85]
    v_mfma_f32_16x16x32_bf16 v[32:35], v[120:123], v[16:19], 0
    v_mfma_f32_16x16x32_bf16 v[32:35], v[124:127], v[20:23], v[32:35]
    v_mov_b32_dpp v52, v28 quad_perm:[0,0,0,0] row_mask:0xf bank_mask:0xf
    v_add_f32_dpp v52, v29, v52 quad_perm:[1,1,1,1] row_mask:0xf bank_mask:0xf
    v_add_f32_dpp v52, v30, v52 quad_perm:[2,2,2,2] row_mask:0xf bank_mask:0xf
    v_add_f32_dpp v52, v31, v52 quad_perm:[3,3,3,3] row_mask:0xf bank_mask:0xf
    v_cvt_pk_bf16_f32 v52, 0, v52
    v_mul_f32 v52, 1035273459, v52
    s_nop 1
    v_mov_b32_dpp v53, v32 quad_perm:[0,0,0,0] row_mask:0xf bank_mask:0xf
    v_add_f32_dpp v53, v33, v53 quad_perm:[1,1,1,1] row_mask:0xf bank_mask:0xf
    v_add_f32_dpp v53, v34, v53 quad_perm:[2,2,2,2] row_mask:0xf bank_mask:0xf
    v_add_f32_dpp v53, v35, v53 quad_perm:[3,3,3,3] row_mask:0xf bank_mask:0xf
    v_cvt_pk_bf16_f32 v53, 0, v53
    v_mul_f32 v53, 1035273459, v53
    v_cvt_pk_bf16_f32 v47, v52, v53
    v_cndmask_b32 v46, v46, v47, s[86:87]
    ds_write_b32 v1, v46
    v_add_u32 v1, 256, v1
    s_xor_b32 s48, s48, 32768
    s_waitcnt vmcnt(6)
    buffer_load_dwordx4 v[80:83], v2, s[36:39], s48 offen nt
    v_mfma_f32_16x16x32_bf16 v[28:31], v[128:131], v[16:19], 0
    v_mfma_f32_16x16x32_bf16 v[28:31], v[132:135], v[20:23], v[28:31]
    v_mfma_f32_16x16x32_bf16 v[32:35], v[136:139], v[16:19], 0
    v_mfma_f32_16x16x32_bf16 v[32:35], v[140:143], v[20:23], v[32:35]
    s_nop 5
    v_mov_b32_dpp v52, v28 quad_perm:[0,0,0,0] row_mask:0xf bank_mask:0xf
    v_add_f32_dpp v52, v29, v52 quad_perm:[1,1,1,1] row_mask:0xf bank_mask:0xf
    v_add_f32_dpp v52, v30, v52 quad_perm:[2,2,2,2] row_mask:0xf bank_mask:0xf
    v_add_f32_dpp v52, v31, v52 quad_perm:[3,3,3,3] row_mask:0xf bank_mask:0xf
    v_cvt_pk_bf16_f32 v52, 0, v52
    v_mul_f32 v52, 1035273459, v52
    s_waitcnt vmcnt(6)
    buffer_load_dwordx4 v[84:87], v3, s[36:39], s48 offen nt
    v_mfma_f32_16x16x32_bf16 v[28:31], v[144:147], v[16:19], 0
    v_mfma_f32_16x16x32_bf16 v[28:31], v[148:151], v[20:23], v[28:31]
    v_mov_b32_dpp v53, v32 quad_perm:[0,0,0,0] row_mask:0xf bank_mask:0xf
    v_add_f32_dpp v53, v33, v53 quad_perm:[1,1,1,1] row_mask:0xf bank_mask:0xf
    v_add_f32_dpp v53, v34, v53 quad_perm:[2,2,2,2] row_mask:0xf bank_mask:0xf
    v_add_f32_dpp v53, v35, v53 quad_perm:[3,3,3,3] row_mask:0xf bank_mask:0xf
    v_cvt_pk_bf16_f32 v53, 0, v53
    v_mul_f32 v53, 1035273459, v53
    v_cvt_pk_bf16_f32 v46, v52, v53
    v_mfma_f32_16x16x32_bf16 v[32:35], v[152:155], v[16:19], 0
    v_mfma_f32_16x16x32_bf16 v[32:35], v[156:159], v[20:23], v[32:35]
    v_mov_b32_dpp v52, v28 quad_perm:[0,0,0,0] row_mask:0xf bank_mask:0xf
    v_add_f32_dpp v52, v29, v52 quad_perm:[1,1,1,1] row_mask:0xf bank_mask:0xf
    v_add_f32_dpp v52, v30, v52 quad_perm:[2,2,2,2] row_mask:0xf bank_mask:0xf
    v_add_f32_dpp v52, v31, v52 quad_perm:[3,3,3,3] row_mask:0xf bank_mask:0xf
    v_cvt_pk_bf16_f32 v52, 0, v52
    v_mul_f32 v52, 1035273459, v52
    s_waitcnt vmcnt(6)
    buffer_load_dwordx4 v[88:91], v4, s[36:39], s48 offen nt
    v_mfma_f32_16x16x32_bf16 v[28:31], v[160:163], v[16:19], 0
    v_mfma_f32_16x16x32_bf16 v[28:31], v[164:167], v[20:23], v[28:31]
    v_mov_b32_dpp v53, v32 quad_perm:[0,0,0,0] row_mask:0xf bank_mask:0xf
    v_add_f32_dpp v53, v33, v53 quad_perm:[1,1,1,1] row_mask:0xf bank_mask:0xf
    v_add_f32_dpp v53, v34, v53 quad_perm:[2,2,2,2] row_mask:0xf bank_mask:0xf
    v_add_f32_dpp v53, v35, v53 quad_perm:[3,3,3,3] row_mask:0xf bank_mask:0xf
    v_cvt_pk_bf16_f32 v53, 0, v53
    v_mul_f32 v53, 1035273459, v53
    v_cvt_pk_bf16_f32 v47, v52, v53
    v_cndmask_b32 v46, v46, v47, s[82:83]
    v_mfma_f32_16x16x32_bf16 v[32:35], v[168:171], v[16:19], 0
    v_mfma_f32_16x16x32_bf16 v[32:35], v[172:175], v[20:23], v[32:35]
    v_mov_b32_dpp v52, v28 quad_perm:[0,0,0,0] row_mask:0xf bank_mask:0xf
    v_add_f32_dpp v52, v29, v52 quad_perm:[1,1,1,1] row_mask:0xf bank_mask:0xf
    v_add_f32_dpp v52, v30, v52 quad_perm:[2,2,2,2] row_mask:0xf bank_mask:0xf
    v_add_f32_dpp v52, v31, v52 quad_perm:[3,3,3,3] row_mask:0xf bank_mask:0xf
    v_cvt_pk_bf16_f32 v52, 0, v52
    v_mul_f32 v52, 1035273459, v52
    v_mfma_f32_16x16x32_bf16 v[28:31], v[176:179], v[16:19], 0
    s_waitcnt vmcnt(6)
    buffer_load_dwordx4 v[92:95], v5, s[36:39], s48 offen nt
    v_mfma_f32_16x16x32_bf16 v[28:31], v[180:183], v[20:23], v[28:31]
    v_mov_b32_dpp v53, v32 quad_perm:[0,0,0,0] row_mask:0xf bank_mask:0xf
    v_add_f32_dpp v53, v33, v53 quad_perm:[1,1,1,1] row_mask:0xf bank_mask:0xf
    v_add_f32_dpp v53, v34, v53 quad_perm:[2,2,2,2] row_mask:0xf bank_mask:0xf
    v_add_f32_dpp v53, v35, v53 quad_perm:[3,3,3,3] row_mask:0xf bank_mask:0xf
    v_cvt_pk_bf16_f32 v53, 0, v53
    v_mul_f32 v53, 1035273459, v53
    v_cvt_pk_bf16_f32 v47, v52, v53
    v_cndmask_b32 v46, v46, v47, s[84:85]
    v_mfma_f32_16x16x32_bf16 v[32:35], v[184:187], v[16:19], 0
    v_mfma_f32_16x16x32_bf16 v[32:35], v[188:191], v[20:23], v[32:35]
    v_mov_b32_dpp v52, v28 quad_perm:[0,0,0,0] row_mask:0xf bank_mask:0xf
    v_add_f32_dpp v52, v29, v52 quad_perm:[1,1,1,1] row_mask:0xf bank_mask:0xf
    v_add_f32_dpp v52, v30, v52 quad_perm:[2,2,2,2] row_mask:0xf bank_mask:0xf
    v_add_f32_dpp v52, v31, v52 quad_perm:[3,3,3,3] row_mask:0xf bank_mask:0xf
    v_cvt_pk_bf16_f32 v52, 0, v52
    v_mul_f32 v52, 1035273459, v52
    s_nop 1
    v_mov_b32_dpp v53, v32 quad_perm:[0,0,0,0] row_mask:0xf bank_mask:0xf
    v_add_f32_dpp v53, v33, v53 quad_perm:[1,1,1,1] row_mask:0xf bank_mask:0xf
    v_add_f32_dpp v53, v34, v53 quad_perm:[2,2,2,2] row_mask:0xf bank_mask:0xf
    v_add_f32_dpp v53, v35, v53 quad_perm:[3,3,3,3] row_mask:0xf bank_mask:0xf
    v_cvt_pk_bf16_f32 v53, 0, v53
    v_mul_f32 v53, 1035273459, v53
    v_cvt_pk_bf16_f32 v47, v52, v53
    v_cndmask_b32 v46, v46, v47, s[86:87]
    ds_write_b32 v1, v46
    v_add_u32 v1, 256, v1
    v_mfma_f32_16x16x32_bf16 v[28:31], v[192:195], v[16:19], 0
    s_xor_b32 s48, s48, 98304
    s_waitcnt vmcnt(6)
    buffer_load_dwordx4 v[96:99], v2, s[36:39], s48 offen nt
    v_mfma_f32_16x16x32_bf16 v[28:31], v[196:199], v[20:23], v[28:31]
    v_mfma_f32_16x16x32_bf16 v[32:35], v[200:203], v[16:19], 0
    v_mfma_f32_16x16x32_bf16 v[32:35], v[204:207], v[20:23], v[32:35]
    s_nop 5
    v_mov_b32_dpp v52, v28 quad_perm:[0,0,0,0] row_mask:0xf bank_mask:0xf
    v_add_f32_dpp v52, v29, v52 quad_perm:[1,1,1,1] row_mask:0xf bank_mask:0xf
    v_add_f32_dpp v52, v30, v52 quad_perm:[2,2,2,2] row_mask:0xf bank_mask:0xf
    v_add_f32_dpp v52, v31, v52 quad_perm:[3,3,3,3] row_mask:0xf bank_mask:0xf
    v_cvt_pk_bf16_f32 v52, 0, v52
    v_mul_f32 v52, 1035273459, v52
    v_mfma_f32_16x16x32_bf16 v[28:31], v[208:211], v[16:19], 0
    s_waitcnt vmcnt(6)
    buffer_load_dwordx4 v[100:103], v3, s[36:39], s48 offen nt
    v_mfma_f32_16x16x32_bf16 v[28:31], v[212:215], v[20:23], v[28:31]
    v_mov_b32_dpp v53, v32 quad_perm:[0,0,0,0] row_mask:0xf bank_mask:0xf
    v_add_f32_dpp v53, v33, v53 quad_perm:[1,1,1,1] row_mask:0xf bank_mask:0xf
    v_add_f32_dpp v53, v34, v53 quad_perm:[2,2,2,2] row_mask:0xf bank_mask:0xf
    v_add_f32_dpp v53, v35, v53 quad_perm:[3,3,3,3] row_mask:0xf bank_mask:0xf
    v_cvt_pk_bf16_f32 v53, 0, v53
    v_mul_f32 v53, 1035273459, v53
    v_cvt_pk_bf16_f32 v46, v52, v53
    v_mfma_f32_16x16x32_bf16 v[32:35], v[216:219], v[16:19], 0
    v_mfma_f32_16x16x32_bf16 v[32:35], v[220:223], v[20:23], v[32:35]
    v_mov_b32_dpp v52, v28 quad_perm:[0,0,0,0] row_mask:0xf bank_mask:0xf
    v_add_f32_dpp v52, v29, v52 quad_perm:[1,1,1,1] row_mask:0xf bank_mask:0xf
    v_add_f32_dpp v52, v30, v52 quad_perm:[2,2,2,2] row_mask:0xf bank_mask:0xf
    v_add_f32_dpp v52, v31, v52 quad_perm:[3,3,3,3] row_mask:0xf bank_mask:0xf
    v_cvt_pk_bf16_f32 v52, 0, v52
    v_mul_f32 v52, 1035273459, v52
    v_mfma_f32_16x16x32_bf16 v[28:31], v[224:227], v[16:19], 0
    v_mfma_f32_16x16x32_bf16 v[28:31], v[228:231], v[20:23], v[28:31]
    v_mov_b32_dpp v53, v32 quad_perm:[0,0,0,0] row_mask:0xf bank_mask:0xf
    v_add_f32_dpp v53, v33, v53 quad_perm:[1,1,1,1] row_mask:0xf bank_mask:0xf
    v_add_f32_dpp v53, v34, v53 quad_perm:[2,2,2,2] row_mask:0xf bank_mask:0xf
    v_add_f32_dpp v53, v35, v53 quad_perm:[3,3,3,3] row_mask:0xf bank_mask:0xf
    v_cvt_pk_bf16_f32 v53, 0, v53
    v_mul_f32 v53, 1035273459, v53
    v_cvt_pk_bf16_f32 v47, v52, v53
    v_cndmask_b32 v46, v46, v47, s[82:83]
    s_waitcnt vmcnt(6)
    buffer_load_dwordx4 v[104:107], v4, s[36:39], s48 offen nt
    v_mfma_f32_16x16x32_bf16 v[32:35], v[232:235], v[16:19], 0
    v_mfma_f32_16x16x32_bf16 v[32:35], v[236:239], v[20:23], v[32:35]
    v_mov_b32_dpp v52, v28 quad_perm:[0,0,0,0] row_mask:0xf bank_mask:0xf
    v_add_f32_dpp v52, v29, v52 quad_perm:[1,1,1,1] row_mask:0xf bank_mask:0xf
    v_add_f32_dpp v52, v30, v52 quad_perm:[2,2,2,2] row_mask:0xf bank_mask:0xf
    v_add_f32_dpp v52, v31, v52 quad_perm:[3,3,3,3] row_mask:0xf bank_mask:0xf
    v_cvt_pk_bf16_f32 v52, 0, v52
    v_mul_f32 v52, 1035273459, v52
    v_mfma_f32_16x16x32_bf16 v[28:31], v[240:243], v[16:19], 0
    v_mfma_f32_16x16x32_bf16 v[28:31], v[244:247], v[20:23], v[28:31]
    v_mov_b32_dpp v53, v32 quad_perm:[0,0,0,0] row_mask:0xf bank_mask:0xf
    v_add_f32_dpp v53, v33, v53 quad_perm:[1,1,1,1] row_mask:0xf bank_mask:0xf
    v_add_f32_dpp v53, v34, v53 quad_perm:[2,2,2,2] row_mask:0xf bank_mask:0xf
    v_add_f32_dpp v53, v35, v53 quad_perm:[3,3,3,3] row_mask:0xf bank_mask:0xf
    v_cvt_pk_bf16_f32 v53, 0, v53
    v_mul_f32 v53, 1035273459, v53
    v_cvt_pk_bf16_f32 v47, v52, v53
    v_cndmask_b32 v46, v46, v47, s[84:85]
    s_waitcnt vmcnt(6)
    buffer_load_dwordx4 v[108:111], v5, s[36:39], s48 offen nt
    v_mfma_f32_16x16x32_bf16 v[32:35], v[248:251], v[16:19], 0
    v_mfma_f32_16x16x32_bf16 v[32:35], v[252:255], v[20:23], v[32:35]
    v_mov_b32_dpp v52, v28 quad_perm:[0,0,0,0] row_mask:0xf bank_mask:0xf
    v_add_f32_dpp v52, v29, v52 quad_perm:[1,1,1,1] row_mask:0xf bank_mask:0xf
    v_add_f32_dpp v52, v30, v52 quad_perm:[2,2,2,2] row_mask:0xf bank_mask:0xf
    v_add_f32_dpp v52, v31, v52 quad_perm:[3,3,3,3] row_mask:0xf bank_mask:0xf
    v_cvt_pk_bf16_f32 v52, 0, v52
    v_mul_f32 v52, 1035273459, v52
    s_nop 1
    v_mov_b32_dpp v53, v32 quad_perm:[0,0,0,0] row_mask:0xf bank_mask:0xf
    v_add_f32_dpp v53, v33, v53 quad_perm:[1,1,1,1] row_mask:0xf bank_mask:0xf
    v_add_f32_dpp v53, v34, v53 quad_perm:[2,2,2,2] row_mask:0xf bank_mask:0xf
    v_add_f32_dpp v53, v35, v53 quad_perm:[3,3,3,3] row_mask:0xf bank_mask:0xf
    v_cvt_pk_bf16_f32 v53, 0, v53
    v_mul_f32 v53, 1035273459, v53
    v_cvt_pk_bf16_f32 v47, v52, v53
    v_cndmask_b32 v46, v46, v47, s[86:87]
    ds_write_b32 v1, v46
    v_add_u32 v1, 256, v1
    ds_read_b128 v[128:131], v44 offset:0
    ds_read_b128 v[132:135], v44 offset:1024
    ds_read_b128 v[136:139], v44 offset:2048
    ds_read_b128 v[140:143], v44 offset:3072
    ds_read_b128 v[144:147], v44 offset:4096
    ds_read_b128 v[148:151], v44 offset:5120
    ds_read_b128 v[152:155], v44 offset:6144
    ds_read_b128 v[156:159], v44 offset:7168
    ds_read_b128 v[160:163], v44 offset:8192
    ds_read_b128 v[164:167], v44 offset:9216
    ds_read_b128 v[168:171], v44 offset:10240
    ds_read_b128 v[172:175], v44 offset:11264
    ds_read_b128 v[176:179], v44 offset:12288
    ds_read_b128 v[180:183], v44 offset:13312
    ds_read_b128 v[184:187], v44 offset:14336
    ds_read_b128 v[188:191], v44 offset:15360
    s_waitcnt lgkmcnt(12)
    v_mfma_f32_16x16x32_bf16 v[28:31], v[128:131], v[16:19], 0
    v_mfma_f32_16x16x32_bf16 v[28:31], v[132:135], v[20:23], v[28:31]
    s_xor_b32 s48, s48, 32768
    s_waitcnt vmcnt(6)
    buffer_load_dwordx4 v[112:115], v2, s[36:39], s48 offen nt
    v_mfma_f32_16x16x32_bf16 v[32:35], v[136:139], v[16:19], 0
    v_mfma_f32_16x16x32_bf16 v[32:35], v[140:143], v[20:23], v[32:35]
    s_nop 2
    v_mov_b32_dpp v52, v28 quad_perm:[0,0,0,0] row_mask:0xf bank_mask:0xf
    v_add_f32_dpp v52, v29, v52 quad_perm:[1,1,1,1] row_mask:0xf bank_mask:0xf
    v_add_f32_dpp v52, v30, v52 quad_perm:[2,2,2,2] row_mask:0xf bank_mask:0xf
    v_add_f32_dpp v52, v31, v52 quad_perm:[3,3,3,3] row_mask:0xf bank_mask:0xf
    v_cvt_pk_bf16_f32 v52, 0, v52
    v_mul_f32 v52, 1035273459, v52
    s_waitcnt lgkmcnt(8)
    v_mfma_f32_16x16x32_bf16 v[28:31], v[144:147], v[16:19], 0
    v_mfma_f32_16x16x32_bf16 v[28:31], v[148:151], v[20:23], v[28:31]
    v_mov_b32_dpp v53, v32 quad_perm:[0,0,0,0] row_mask:0xf bank_mask:0xf
    v_add_f32_dpp v53, v33, v53 quad_perm:[1,1,1,1] row_mask:0xf bank_mask:0xf
    v_add_f32_dpp v53, v34, v53 quad_perm:[2,2,2,2] row_mask:0xf bank_mask:0xf
    v_add_f32_dpp v53, v35, v53 quad_perm:[3,3,3,3] row_mask:0xf bank_mask:0xf
    v_cvt_pk_bf16_f32 v53, 0, v53
    v_mul_f32 v53, 1035273459, v53
    v_cvt_pk_bf16_f32 v46, v52, v53
    v_mfma_f32_16x16x32_bf16 v[32:35], v[152:155], v[16:19], 0
    s_waitcnt vmcnt(6)
    buffer_load_dwordx4 v[116:119], v3, s[36:39], s48 offen nt
    v_mfma_f32_16x16x32_bf16 v[32:35], v[156:159], v[20:23], v[32:35]
    v_mov_b32_dpp v52, v28 quad_perm:[0,0,0,0] row_mask:0xf bank_mask:0xf
    v_add_f32_dpp v52, v29, v52 quad_perm:[1,1,1,1] row_mask:0xf bank_mask:0xf
    v_add_f32_dpp v52, v30, v52 quad_perm:[2,2,2,2] row_mask:0xf bank_mask:0xf
    v_add_f32_dpp v52, v31, v52 quad_perm:[3,3,3,3] row_mask:0xf bank_mask:0xf
    v_cvt_pk_bf16_f32 v52, 0, v52
    v_mul_f32 v52, 1035273459, v52
    s_waitcnt lgkmcnt(4)
    v_mfma_f32_16x16x32_bf16 v[28:31], v[160:163], v[16:19], 0
    v_mfma_f32_16x16x32_bf16 v[28:31], v[164:167], v[20:23], v[28:31]
    v_mov_b32_dpp v53, v32 quad_perm:[0,0,0,0] row_mask:0xf bank_mask:0xf
    v_add_f32_dpp v53, v33, v53 quad_perm:[1,1,1,1] row_mask:0xf bank_mask:0xf
    v_add_f32_dpp v53, v34, v53 quad_perm:[2,2,2,2] row_mask:0xf bank_mask:0xf
    v_add_f32_dpp v53, v35, v53 quad_perm:[3,3,3,3] row_mask:0xf bank_mask:0xf
    v_cvt_pk_bf16_f32 v53, 0, v53
    v_mul_f32 v53, 1035273459, v53
    v_cvt_pk_bf16_f32 v47, v52, v53
    v_cndmask_b32 v46, v46, v47, s[82:83]
    v_mfma_f32_16x16x32_bf16 v[32:35], v[168:171], v[16:19], 0
    s_waitcnt vmcnt(6)
    buffer_load_dwordx4 v[120:123], v4, s[36:39], s48 offen nt
    v_mfma_f32_16x16x32_bf16 v[32:35], v[172:175], v[20:23], v[32:35]
    v_mov_b32_dpp v52, v28 quad_perm:[0,0,0,0] row_mask:0xf bank_mask:0xf
    v_add_f32_dpp v52, v29, v52 quad_perm:[1,1,1,1] row_mask:0xf bank_mask:0xf
    v_add_f32_dpp v52, v30, v52 quad_perm:[2,2,2,2] row_mask:0xf bank_mask:0xf
    v_add_f32_dpp v52, v31, v52 quad_perm:[3,3,3,3] row_mask:0xf bank_mask:0xf
    v_cvt_pk_bf16_f32 v52, 0, v52
    v_mul_f32 v52, 1035273459, v52
    s_waitcnt lgkmcnt(0)
    v_mfma_f32_16x16x32_bf16 v[28:31], v[176:179], v[16:19], 0
    v_mfma_f32_16x16x32_bf16 v[28:31], v[180:183], v[20:23], v[28:31]
    v_mov_b32_dpp v53, v32 quad_perm:[0,0,0,0] row_mask:0xf bank_mask:0xf
    v_add_f32_dpp v53, v33, v53 quad_perm:[1,1,1,1] row_mask:0xf bank_mask:0xf
    v_add_f32_dpp v53, v34, v53 quad_perm:[2,2,2,2] row_mask:0xf bank_mask:0xf
    v_add_f32_dpp v53, v35, v53 quad_perm:[3,3,3,3] row_mask:0xf bank_mask:0xf
    v_cvt_pk_bf16_f32 v53, 0, v53
    v_mul_f32 v53, 1035273459, v53
    v_cvt_pk_bf16_f32 v47, v52, v53
    v_cndmask_b32 v46, v46, v47, s[84:85]
    v_mfma_f32_16x16x32_bf16 v[32:35], v[184:187], v[16:19], 0
    s_waitcnt vmcnt(6)
    buffer_load_dwordx4 v[124:127], v5, s[36:39], s48 offen nt
    v_mfma_f32_16x16x32_bf16 v[32:35], v[188:191], v[20:23], v[32:35]
    v_mov_b32_dpp v52, v28 quad_perm:[0,0,0,0] row_mask:0xf bank_mask:0xf
    v_add_f32_dpp v52, v29, v52 quad_perm:[1,1,1,1] row_mask:0xf bank_mask:0xf
    v_add_f32_dpp v52, v30, v52 quad_perm:[2,2,2,2] row_mask:0xf bank_mask:0xf
    v_add_f32_dpp v52, v31, v52 quad_perm:[3,3,3,3] row_mask:0xf bank_mask:0xf
    v_cvt_pk_bf16_f32 v52, 0, v52
    v_mul_f32 v52, 1035273459, v52
    s_nop 1
    v_mov_b32_dpp v53, v32 quad_perm:[0,0,0,0] row_mask:0xf bank_mask:0xf
    v_add_f32_dpp v53, v33, v53 quad_perm:[1,1,1,1] row_mask:0xf bank_mask:0xf
    v_add_f32_dpp v53, v34, v53 quad_perm:[2,2,2,2] row_mask:0xf bank_mask:0xf
    v_add_f32_dpp v53, v35, v53 quad_perm:[3,3,3,3] row_mask:0xf bank_mask:0xf
    v_cvt_pk_bf16_f32 v53, 0, v53
    v_mul_f32 v53, 1035273459, v53
    v_cvt_pk_bf16_f32 v47, v52, v53
    v_cndmask_b32 v46, v46, v47, s[86:87]
    ds_write_b32 v1, v46
    v_add_u32 v1, 256, v1
    s_lshl_b32 s47, s92, 10
    s_sub_u32 s53, s47, 1073741824
    s_add_u32 s47, s47, 1073741824
    s_mov_b32 s44, 4
    s_mov_b32 s54, 218112
    s_mov_b32 s52, 0
    s_add_u32 s50, s28, 204800
    s_addc_u32 s51, s29, 0
    s_lshl_b32 s57, s97, 1
    s_xor_b32 s57, s57, s98
    s_and_b32 s57, s57, 15
    s_lshl_b32 s56, s3, 4
    s_or_b32 s57, s57, s56
    s_cmp_eq_u32 s57, 1
    s_cselect_b32 s55, 0, -1
    v_mfma_f32_16x16x32_bf16 v[28:31], v[64:67], v[16:19], 0
    v_mfma_f32_16x16x32_bf16 v[28:31], v[68:71], v[20:23], v[28:31]
    v_mfma_f32_16x16x32_bf16 v[32:35], v[72:75], v[16:19], 0
    v_mfma_f32_16x16x32_bf16 v[32:35], v[76:79], v[20:23], v[32:35]
    s_nop 5
    v_mov_b32_dpp v52, v28 quad_perm:[0,0,0,0] row_mask:0xf bank_mask:0xf
    v_add_f32_dpp v52, v29, v52 quad_perm:[1,1,1,1] row_mask:0xf bank_mask:0xf
    v_add_f32_dpp v52, v30, v52 quad_perm:[2,2,2,2] row_mask:0xf bank_mask:0xf
    v_add_f32_dpp v52, v31, v52 quad_perm:[3,3,3,3] row_mask:0xf bank_mask:0xf
    v_cvt_pk_bf16_f32 v52, 0, v52
    v_mul_f32 v52, 1035273459, v52
    v_mfma_f32_16x16x32_bf16 v[28:31], v[80:83], v[16:19], 0
    v_mfma_f32_16x16x32_bf16 v[28:31], v[84:87], v[20:23], v[28:31]
    v_mov_b32_dpp v53, v32 quad_perm:[0,0,0,0] row_mask:0xf bank_mask:0xf
    v_add_f32_dpp v53, v33, v53 quad_perm:[1,1,1,1] row_mask:0xf bank_mask:0xf
    v_add_f32_dpp v53, v34, v53 quad_perm:[2,2,2,2] row_mask:0xf bank_mask:0xf
    v_add_f32_dpp v53, v35, v53 quad_perm:[3,3,3,3] row_mask:0xf bank_mask:0xf
    v_cvt_pk_bf16_f32 v53, 0, v53
    v_mul_f32 v53, 1035273459, v53
    v_cvt_pk_bf16_f32 v46, v52, v53
    v_mfma_f32_16x16x32_bf16 v[32:35], v[88:91], v[16:19], 0
    v_mfma_f32_16x16x32_bf16 v[32:35], v[92:95], v[20:23], v[32:35]
    v_mov_b32_dpp v52, v28 quad_perm:[0,0,0,0] row_mask:0xf bank_mask:0xf
    v_add_f32_dpp v52, v29, v52 quad_perm:[1,1,1,1] row_mask:0xf bank_mask:0xf
    v_add_f32_dpp v52, v30, v52 quad_perm:[2,2,2,2] row_mask:0xf bank_mask:0xf
    v_add_f32_dpp v52, v31, v52 quad_perm:[3,3,3,3] row_mask:0xf bank_mask:0xf
    v_cvt_pk_bf16_f32 v52, 0, v52
    v_mul_f32 v52, 1035273459, v52
    v_mfma_f32_16x16x32_bf16 v[28:31], v[96:99], v[16:19], 0
    s_xor_b32 s48, s94, s49
    s_sub_u32 s94, s94, 1966080
    s_and_b32 s94, s94, 1966080
    s_waitcnt vmcnt(4)
    buffer_load_dwordx4 v[64:67], v2, s[36:39], s48 offen nt
    v_mfma_f32_16x16x32_bf16 v[28:31], v[100:103], v[20:23], v[28:31]
    v_mov_b32_dpp v53, v32 quad_perm:[0,0,0,0] row_mask:0xf bank_mask:0xf
    v_add_f32_dpp v53, v33, v53 quad_perm:[1,1,1,1] row_mask:0xf bank_mask:0xf
    v_add_f32_dpp v53, v34, v53 quad_perm:[2,2,2,2] row_mask:0xf bank_mask:0xf
    v_add_f32_dpp v53, v35, v53 quad_perm:[3,3,3,3] row_mask:0xf bank_mask:0xf
    v_cvt_pk_bf16_f32 v53, 0, v53
    v_mul_f32 v53, 1035273459, v53
    v_cvt_pk_bf16_f32 v47, v52, v53
    v_cndmask_b32 v46, v46, v47, s[82:83]
    s_waitcnt vmcnt(4)
    buffer_load_dwordx4 v[68:71], v3, s[36:39], s48 offen nt
    v_mfma_f32_16x16x32_bf16 v[32:35], v[104:107], v[16:19], 0
    s_waitcnt vmcnt(4)
    buffer_load_dwordx4 v[72:75], v4, s[36:39], s48 offen nt
    v_mfma_f32_16x16x32_bf16 v[32:35], v[108:111], v[20:23], v[32:35]
    v_mov_b32_dpp v52, v28 quad_perm:[0,0,0,0] row_mask:0xf bank_mask:0xf
    v_add_f32_dpp v52, v29, v52 quad_perm:[1,1,1,1] row_mask:0xf bank_mask:0xf
    v_add_f32_dpp v52, v30, v52 quad_perm:[2,2,2,2] row_mask:0xf bank_mask:0xf
    v_add_f32_dpp v52, v31, v52 quad_perm:[3,3,3,3] row_mask:0xf bank_mask:0xf
    v_cvt_pk_bf16_f32 v52, 0, v52
    v_mul_f32 v52, 1035273459, v52
    s_waitcnt vmcnt(4)
    buffer_load_dwordx4 v[76:79], v5, s[36:39], s48 offen nt
    v_mfma_f32_16x16x32_bf16 v[28:31], v[112:115], v[16:19], 0
    s_xor_b32 s48, s48, 32768
    s_waitcnt vmcnt(4)
    buffer_load_dwordx4 v[80:83], v2, s[36:39], s48 offen nt
    v_mfma_f32_16x16x32_bf16 v[28:31], v[116:119], v[20:23], v[28:31]
    v_mov_b32_dpp v53, v32 quad_perm:[0,0,0,0] row_mask:0xf bank_mask:0xf
    v_add_f32_dpp v53, v33, v53 quad_perm:[1,1,1,1] row_mask:0xf bank_mask:0xf
    v_add_f32_dpp v53, v34, v53 quad_perm:[2,2,2,2] row_mask:0xf bank_mask:0xf
    v_add_f32_dpp v53, v35, v53 quad_perm:[3,3,3,3] row_mask:0xf bank_mask:0xf
    v_cvt_pk_bf16_f32 v53, 0, v53
    v_mul_f32 v53, 1035273459, v53
    v_cvt_pk_bf16_f32 v47, v52, v53
    v_cndmask_b32 v46, v46, v47, s[84:85]
    s_waitcnt vmcnt(4)
    buffer_load_dwordx4 v[84:87], v3, s[36:39], s48 offen nt
    v_mfma_f32_16x16x32_bf16 v[32:35], v[120:123], v[16:19], 0
    s_waitcnt vmcnt(4)
    buffer_load_dwordx4 v[88:91], v4, s[36:39], s48 offen nt
    v_mfma_f32_16x16x32_bf16 v[32:35], v[124:127], v[20:23], v[32:35]
    v_mov_b32_dpp v52, v28 quad_perm:[0,0,0,0] row_mask:0xf bank_mask:0xf
    v_add_f32_dpp v52, v29, v52 quad_perm:[1,1,1,1] row_mask:0xf bank_mask:0xf
    v_add_f32_dpp v52, v30, v52 quad_perm:[2,2,2,2] row_mask:0xf bank_mask:0xf
    v_add_f32_dpp v52, v31, v52 quad_perm:[3,3,3,3] row_mask:0xf bank_mask:0xf
    v_cvt_pk_bf16_f32 v52, 0, v52
    v_mul_f32 v52, 1035273459, v52
    s_nop 1
    v_mov_b32_dpp v53, v32 quad_perm:[0,0,0,0] row_mask:0xf bank_mask:0xf
    v_add_f32_dpp v53, v33, v53 quad_perm:[1,1,1,1] row_mask:0xf bank_mask:0xf
    v_add_f32_dpp v53, v34, v53 quad_perm:[2,2,2,2] row_mask:0xf bank_mask:0xf
    v_add_f32_dpp v53, v35, v53 quad_perm:[3,3,3,3] row_mask:0xf bank_mask:0xf
    v_cvt_pk_bf16_f32 v53, 0, v53
    v_mul_f32 v53, 1035273459, v53
    v_cvt_pk_bf16_f32 v47, v52, v53
    v_cndmask_b32 v46, v46, v47, s[86:87]
    ds_write_b32 v1, v46
    v_add_u32 v1, 256, v1
    s_mov_b32 s45, 10
L_kloop:
    s_memrealtime s[58:59]
    s_waitcnt lgkmcnt(0)
    s_lshl_b32 s59, s58, 10
    s_and_b32 s56, s44, 3
    s_cmp_lg_u32 s56, 3
    s_cbranch_scc1 L_c1_60
    s_add_u32 s52, s52, 1
    s_lshr_b32 s57, s52, 27
    s_cmp_lg_u32 s57, 16
    s_cbranch_scc1 L_c1_60
    s_lshl_b32 s52, s52, 6
    s_sub_u32 s57, s59, s52
    s_cmp_ge_u32 s57, 4194304
    s_cbranch_scc1 L_c1_60
    s_sub_u32 s57, s52, s53
    s_mov_b32 s53, s52
    s_lshr_b32 s57, s57, 2
    s_cmp_lt_u32 s57, 326656
    s_cselect_b32 s57, s57, s54
    s_add_u32 s54, s54, s57
    s_lshr_b32 s54, s54, 1
    s_mul_i32 s57, s54, 3
    s_add_u32 s47, s52, s57
L_c1_60:
    s_cmp_lg_u32 s56, 2
    s_cbranch_scc1 L_c2_61
    s_sub_u32 s57, s44, 2
    s_mul_i32 s57, s57, 160
    s_load_dword s52, s[50:51], s57
L_c2_61:
    s_cmp_lg_u32 s56, s55
    s_cbranch_scc1 L_c3_62
    s_and_b32 s58, s58, 0x3fffff
    s_or_b32 s46, s58, 134217728
    s_mul_i32 s57, s44, 160
    s_atomic_add s46, s[50:51], s57
L_c3_62:
    s_sub_u32 s56, s59, s47
    s_add_u32 s47, s47, s54
    s_add_u32 s44, s44, 1
    s_add_u32 s57, s56, 268435456
    s_cmp_lt_u32 s57, 268343296
    s_cselect_b32 s93, 1, 0
    s_cmp_ge_i32 s56, 46080
    s_cselect_b64 vcc, -1, 0
    s_cmp_eq_u32 s93, 0
    s_cbranch_scc1 L_t3_64
    s_waitcnt vmcnt(3)
L_t3_64:
    s_cbranch_vccnz L_t2_65
    s_waitcnt vmcnt(4)
L_t2_65:
    s_waitcnt vmcnt(6)
    buffer_load_dwordx4 v[92:95], v5, s[36:39], s48 offen nt
    v_mfma_f32_16x16x32_bf16 v[28:31], v[64:67], v[16:19], 0
    s_xor_b32 s48, s48, 98304
    s_cmp_eq_u32 s93, 0
    s_cbranch_scc1 L_t3_66
    s_waitcnt vmcnt(3)
L_t3_66:
    s_cbranch_vccnz L_t2_67
    s_waitcnt vmcnt(4)
L_t2_67:
    s_waitcnt vmcnt(6)
    buffer_load_dwordx4 v[96:99], v2, s[36:39], s48 offen nt
    v_mfma_f32_16x16x32_bf16 v[28:31], v[68:71], v[20:23], v[28:31]
    s_cbranch_scc1 L_t3_68
    s_waitcnt vmcnt(3)
L_t3_68:
    s_cbranch_vccnz L_t2_69
    s_waitcnt vmcnt(4)
L_t2_69:
    s_waitcnt vmcnt(6)
    buffer_load_dwordx4 v[100:103], v3, s[36:39], s48 offen nt
    v_mfma_f32_16x16x32_bf16 v[32:35], v[72:75], v[16:19], 0
    s_cbranch_scc1 L_t3_70
    s_waitcnt vmcnt(3)
L_t3_70:
    s_cbranch_vccnz L_t2_71
    s_waitcnt vmcnt(4)
L_t2_71:
    s_waitcnt vmcnt(6)
    buffer_load_dwordx4 v[104:107], v4, s[36:39], s48 offen nt
    v_mfma_f32_16x16x32_bf16 v[32:35], v[76:79], v[20:23], v[32:35]
    v_mov_b32_dpp v52, v28 quad_perm:[0,0,0,0] row_mask:0xf bank_mask:0xf
    v_add_f32_dpp v52, v29, v52 quad_perm:[1,1,1,1] row_mask:0xf bank_mask:0xf
    v_add_f32_dpp v52, v30, v52 quad_perm:[2,2,2,2] row_mask:0xf bank_mask:0xf
    v_add_f32_dpp v52, v31, v52 quad_perm:[3,3,3,3] row_mask:0xf bank_mask:0xf
    v_cvt_pk_bf16_f32 v52, 0, v52
    v_mul_f32 v52, 1035273459, v52
    s_cbranch_scc1 L_t3_72
    s_waitcnt vmcnt(3)
L_t3_72:
    s_cbranch_vccnz L_t2_73
    s_waitcnt vmcnt(4)
L_t2_73:
    s_waitcnt vmcnt(6)
    buffer_load_dwordx4 v[108:111], v5, s[36:39], s48 offen nt
    v_mfma_f32_16x16x32_bf16 v[28:31], v[80:83], v[16:19], 0
    s_xor_b32 s48, s48, 32768
    s_cmp_eq_u32 s93, 0
    s_cbranch_scc1 L_t3_74
    s_waitcnt vmcnt(3)
L_t3_74:
    s_cbranch_vccnz L_t2_75
    s_waitcnt vmcnt(4)
L_t2_75:
    s_waitcnt vmcnt(6)
    buffer_load_dwordx4 v[112:115], v2, s[36:39], s48 offen nt
    v_mfma_f32_16x16x32_bf16 v[28:31], v[84:87], v[20:23], v[28:31]
    v_mov_b32_dpp v53, v32 quad_perm:[0,0,0,0] row_mask:0xf bank_mask:0xf
    v_add_f32_dpp v53, v33, v53 quad_perm:[1,1,1,1] row_mask:0xf bank_mask:0xf
    v_add_f32_dpp v53, v34, v53 quad_perm:[2,2,2,2] row_mask:0xf bank_mask:0xf
    v_add_f32_dpp v53, v35, v53 quad_perm:[3,3,3,3] row_mask:0xf bank_mask:0xf
    v_cvt_pk_bf16_f32 v53, 0, v53
    v_mul_f32 v53, 1035273459, v53
    v_cvt_pk_bf16_f32 v46, v52, v53
    s_cbranch_scc1 L_t3_76
    s_waitcnt vmcnt(3)
L_t3_76:
    s_cbranch_vccnz L_t2_77
    s_waitcnt vmcnt(4)
L_t2_77:
    s_waitcnt vmcnt(6)
    buffer_load_dwordx4 v[116:119], v3, s[36:39], s48 offen nt
    v_mfma_f32_16x16x32_bf16 v[32:35], v[88:91], v[16:19], 0
    s_cbranch_scc1 L_t3_78
    s_waitcnt vmcnt(3)
L_t3_78:
    s_cbranch_vccnz L_t2_79
    s_waitcnt vmcnt(4)
L_t2_79:
    s_waitcnt vmcnt(6)
    buffer_load_dwordx4 v[120:123], v4, s[36:39], s48 offen nt
    v_mfma_f32_16x16x32_bf16 v[32:35], v[92:95], v[20:23], v[32:35]
    v_mov_b32_dpp v52, v28 quad_perm:[0,0,0,0] row_mask:0xf bank_mask:0xf
    v_add_f32_dpp v52, v29, v52 quad_perm:[1,1,1,1] row_mask:0xf bank_mask:0xf
    v_add_f32_dpp v52, v30, v52 quad_perm:[2,2,2,2] row_mask:0xf bank_mask:0xf
    v_add_f32_dpp v52, v31, v52 quad_perm:[3,3,3,3] row_mask:0xf bank_mask:0xf
    v_cvt_pk_bf16_f32 v52, 0, v52
    v_mul_f32 v52, 1035273459, v52
    s_cbranch_scc1 L_t3_80
    s_waitcnt vmcnt(3)
L_t3_80:
    s_cbranch_vccnz L_t2_81
    s_waitcnt vmcnt(4)
L_t2_81:
    s_waitcnt vmcnt(6)
    buffer_load_dwordx4 v[124:127], v5, s[36:39], s48 offen nt
    v_mfma_f32_16x16x32_bf16 v[28:31], v[96:99], v[16:19], 0
    s_xor_b32 s48, s94, s49
    s_sub_u32 s94, s94, 1966080
    s_and_b32 s94, s94, 1966080
    s_cmp_eq_u32 s93, 0
    s_cbranch_scc1 L_t3_82
    s_waitcnt vmcnt(3)
L_t3_82:
    s_cbranch_vccnz L_t2_83
    s_waitcnt vmcnt(4)
L_t2_83:
    s_waitcnt vmcnt(6)
    buffer_load_dwordx4 v[64:67], v2, s[36:39], s48 offen nt
    v_mfma_f32_16x16x32_bf16 v[28:31], v[100:103], v[20:23], v[28:31]
    v_mov_b32_dpp v53, v32 quad_perm:[0,0,0,0] row_mask:0xf bank_mask:0xf
    v_add_f32_dpp v53, v33, v53 quad_perm:[1,1,1,1] row_mask:0xf bank_mask:0xf
    v_add_f32_dpp v53, v34, v53 quad_perm:[2,2,2,2] row_mask:0xf bank_mask:0xf
    v_add_f32_dpp v53, v35, v53 quad_perm:[3,3,3,3] row_mask:0xf bank_mask:0xf
    v_cvt_pk_bf16_f32 v53, 0, v53
    v_mul_f32 v53, 1035273459, v53
    v_cvt_pk_bf16_f32 v47, v52, v53
    v_cndmask_b32 v46, v46, v47, s[82:83]
    s_cbranch_scc1 L_t3_84
    s_waitcnt vmcnt(3)
L_t3_84:
    s_cbranch_vccnz L_t2_85
    s_waitcnt vmcnt(4)
L_t2_85:
    s_waitcnt vmcnt(6)
    buffer_load_dwordx4 v[68:71], v3, s[36:39], s48 offen nt
    v_mfma_f32_16x16x32_bf16 v[32:35], v[104:107], v[16:19], 0
    s_cbranch_scc1 L_t3_86
    s_waitcnt vmcnt(3)
L_t3_86:
    s_cbranch_vccnz L_t2_87
    s_waitcnt vmcnt(4)
L_t2_87:
    s_waitcnt vmcnt(6)
    buffer_load_dwordx4 v[72:75], v4, s[36:39], s48 offen nt
    v_mfma_f32_16x16x32_bf16 v[32:35], v[108:111], v[20:23], v[32:35]
    v_mov_b32_dpp v52, v28 quad_perm:[0,0,0,0] row_mask:0xf bank_mask:0xf
    v_add_f32_dpp v52, v29, v52 quad_perm:[1,1,1,1] row_mask:0xf bank_mask:0xf
    v_add_f32_dpp v52, v30, v52 quad_perm:[2,2,2,2] row_mask:0xf bank_mask:0xf
    v_add_f32_dpp v52, v31, v52 quad_perm:[3,3,3,3] row_mask:0xf bank_mask:0xf
    v_cvt_pk_bf16_f32 v52, 0, v52
    v_mul_f32 v52, 1035273459, v52
    s_cbranch_scc1 L_t3_88
    s_waitcnt vmcnt(3)
L_t3_88:
    s_cbranch_vccnz L_t2_89
    s_waitcnt vmcnt(4)
L_t2_89:
    s_waitcnt vmcnt(6)
    buffer_load_dwordx4 v[76:79], v5, s[36:39], s48 offen nt
    v_mfma_f32_16x16x32_bf16 v[28:31], v[112:115], v[16:19], 0
    s_xor_b32 s48, s48, 32768
    s_cmp_eq_u32 s93, 0
    s_cbranch_scc1 L_t3_90
    s_waitcnt vmcnt(3)
L_t3_90:
    s_cbranch_vccnz L_t2_91
    s_waitcnt vmcnt(4)
L_t2_91:
    s_waitcnt vmcnt(6)
    buffer_load_dwordx4 v[80:83], v2, s[36:39], s48 offen nt
    v_mfma_f32_16x16x32_bf16 v[28:31], v[116:119], v[20:23], v[28:31]
    v_mov_b32_dpp v53, v32 quad_perm:[0,0,0,0] row_mask:0xf bank_mask:0xf
    v_add_f32_dpp v53, v33, v53 quad_perm:[1,1,1,1] row_mask:0xf bank_mask:0xf
    v_add_f32_dpp v53, v34, v53 quad_perm:[2,2,2,2] row_mask:0xf bank_mask:0xf
    v_add_f32_dpp v53, v35, v53 quad_perm:[3,3,3,3] row_mask:0xf bank_mask:0xf
    v_cvt_pk_bf16_f32 v53, 0, v53
    v_mul_f32 v53, 1035273459, v53
    v_cvt_pk_bf16_f32 v47, v52, v53
    v_cndmask_b32 v46, v46, v47, s[84:85]
    s_cbranch_scc1 L_t3_92
    s_waitcnt vmcnt(3)
L_t3_92:
    s_cbranch_vccnz L_t2_93
    s_waitcnt vmcnt(4)
L_t2_93:
    s_waitcnt vmcnt(6)
    buffer_load_dwordx4 v[84:87], v3, s[36:39], s48 offen nt
    v_mfma_f32_16x16x32_bf16 v[32:35], v[120:123], v[16:19], 0
    s_cbranch_scc1 L_t3_94
    s_waitcnt vmcnt(3)
L_t3_94:
    s_cbranch_vccnz L_t2_95
    s_waitcnt vmcnt(4)
L_t2_95:
    s_waitcnt vmcnt(6)
    buffer_load_dwordx4 v[88:91], v4, s[36:39], s48 offen nt
    v_mfma_f32_16x16x32_bf16 v[32:35], v[124:127], v[20:23], v[32:35]
    v_mov_b32_dpp v52, v28 quad_perm:[0,0,0,0] row_mask:0xf bank_mask:0xf
    v_add_f32_dpp v52, v29, v52 quad_perm:[1,1,1,1] row_mask:0xf bank_mask:0xf
    v_add_f32_dpp v52, v30, v52 quad_perm:[2,2,2,2] row_mask:0xf bank_mask:0xf
    v_add_f32_dpp v52, v31, v52 quad_perm:[3,3,3,3] row_mask:0xf bank_mask:0xf
    v_cvt_pk_bf16_f32 v52, 0, v52
    v_mul_f32 v52, 1035273459, v52
    s_nop 1
    v_mov_b32_dpp v53, v32 quad_perm:[0,0,0,0] row_mask:0xf bank_mask:0xf
    v_add_f32_dpp v53, v33, v53 quad_perm:[1,1,1,1] row_mask:0xf bank_mask:0xf
    v_add_f32_dpp v53, v34, v53 quad_perm:[2,2,2,2] row_mask:0xf bank_mask:0xf
    v_add_f32_dpp v53, v35, v53 quad_perm:[3,3,3,3] row_mask:0xf bank_mask:0xf
    v_cvt_pk_bf16_f32 v53, 0, v53
    v_mul_f32 v53, 1035273459, v53
    v_cvt_pk_bf16_f32 v47, v52, v53
    v_cndmask_b32 v46, v46, v47, s[86:87]
    ds_write_b32 v1, v46
    v_add_u32 v1, 256, v1
    s_sub_u32 s45, s45, 1
    s_cmp_lg_u32 s45, 0
    s_cbranch_scc1 L_kloop
    s_mov_b32 s45, 1
L_klast:
    s_memrealtime s[58:59]
    s_waitcnt lgkmcnt(0)
    s_lshl_b32 s59, s58, 10
    s_and_b32 s56, s44, 3
    s_cmp_lg_u32 s56, 3
    s_cbranch_scc1 L_c1_96
    s_add_u32 s52, s52, 1
    s_lshr_b32 s57, s52, 27
    s_cmp_lg_u32 s57, 16
    s_cbranch_scc1 L_c1_96
    s_lshl_b32 s52, s52, 6
    s_sub_u32 s57, s59, s52
    s_cmp_ge_u32 s57, 4194304
    s_cbranch_scc1 L_c1_96
    s_sub_u32 s57, s52, s53
    s_mov_b32 s53, s52
    s_lshr_b32 s57, s57, 2
    s_cmp_lt_u32 s57, 326656
    s_cselect_b32 s57, s57, s54
    s_add_u32 s54, s54, s57
    s_lshr_b32 s54, s54, 1
    s_mul_i32 s57, s54, 3
    s_add_u32 s47, s52, s57
L_c1_96:
    s_cmp_lg_u32 s56, 2
    s_cbranch_scc1 L_c2_97
    s_sub_u32 s57, s44, 2
    s_mul_i32 s57, s57, 160
    s_load_dword s52, s[50:51], s57
L_c2_97:
    s_cmp_lg_u32 s56, s55
    s_cbranch_scc1 L_c3_98
    s_and_b32 s58, s58, 0x3fffff
    s_or_b32 s46, s58, 134217728
    s_mul_i32 s57, s44, 160
    s_atomic_add s46, s[50:51], s57
L_c3_98:
    s_sub_u32 s56, s59, s47
    s_add_u32 s47, s47, s54
    s_add_u32 s44, s44, 1
    s_add_u32 s57, s56, 268435456
    s_cmp_lt_u32 s57, 268343296
    s_cselect_b32 s93, 1, 0
    s_cmp_ge_i32 s56, 46080
    s_cselect_b64 vcc, -1, 0
    s_cmp_eq_u32 s93, 0
    v_subrev_u32 v55, 3840, v1
    ds_read_b32 v54, v55
    s_cbranch_scc1 L_t3_100
    s_waitcnt vmcnt(3)
L_t3_100:
    s_cbranch_vccnz L_t2_101
    s_waitcnt vmcnt(4)
L_t2_101:
    s_waitcnt vmcnt(6)
    buffer_load_dwordx4 v[92:95], v5, s[36:39], s48 offen nt
    v_mfma_f32_16x16x32_bf16 v[28:31], v[64:67], v[16:19], 0
    s_xor_b32 s48, s48, 98304
    s_cmp_eq_u32 s93, 0
    s_cbranch_scc1 L_t3_102
    s_waitcnt vmcnt(3)
L_t3_102:
    s_cbranch_vccnz L_t2_103
    s_waitcnt vmcnt(4)
L_t2_103:
    s_waitcnt vmcnt(6)
    buffer_load_dwordx4 v[96:99], v2, s[36:39], s48 offen nt
    v_mfma_f32_16x16x32_bf16 v[28:31], v[68:71], v[20:23], v[28:31]
    s_cbranch_scc1 L_t3_104
    s_waitcnt vmcnt(3)
L_t3_104:
    s_cbranch_vccnz L_t2_105
    s_waitcnt vmcnt(4)
L_t2_105:
    s_waitcnt vmcnt(6)
    buffer_load_dwordx4 v[100:103], v3, s[36:39], s48 offen nt
    v_mfma_f32_16x16x32_bf16 v[32:35], v[72:75], v[16:19], 0
    s_cbranch_scc1 L_t3_106
    s_waitcnt vmcnt(3)
L_t3_106:
    s_cbranch_vccnz L_t2_107
    s_waitcnt vmcnt(4)
L_t2_107:
    s_waitcnt vmcnt(6)
    buffer_load_dwordx4 v[104:107], v4, s[36:39], s48 offen nt
    v_mfma_f32_16x16x32_bf16 v[32:35], v[76:79], v[20:23], v[32:35]
    v_mov_b32_dpp v52, v28 quad_perm:[0,0,0,0] row_mask:0xf bank_mask:0xf
    v_add_f32_dpp v52, v29, v52 quad_perm:[1,1,1,1] row_mask:0xf bank_mask:0xf
    v_add_f32_dpp v52, v30, v52 quad_perm:[2,2,2,2] row_mask:0xf bank_mask:0xf
    v_add_f32_dpp v52, v31, v52 quad_perm:[3,3,3,3] row_mask:0xf bank_mask:0xf
    v_cvt_pk_bf16_f32 v52, 0, v52
    v_mul_f32 v52, 1035273459, v52
    s_cbranch_scc1 L_t3_108
    s_waitcnt vmcnt(3)
L_t3_108:
    s_cbranch_vccnz L_t2_109
    s_waitcnt vmcnt(4)
L_t2_109:
    s_waitcnt vmcnt(6)
    buffer_load_dwordx4 v[108:111], v5, s[36:39], s48 offen nt
    v_mfma_f32_16x16x32_bf16 v[28:31], v[80:83], v[16:19], 0
    s_xor_b32 s48, s48, 32768
    s_cmp_eq_u32 s93, 0
    s_cbranch_scc1 L_t3_110
    s_waitcnt vmcnt(3)
L_t3_110:
    s_cbranch_vccnz L_t2_111
    s_waitcnt vmcnt(4)
L_t2_111:
    s_waitcnt vmcnt(6)
    buffer_load_dwordx4 v[112:115], v2, s[36:39], s48 offen nt
    v_mfma_f32_16x16x32_bf16 v[28:31], v[84:87], v[20:23], v[28:31]
    v_mov_b32_dpp v53, v32 quad_perm:[0,0,0,0] row_mask:0xf bank_mask:0xf
    v_add_f32_dpp v53, v33, v53 quad_perm:[1,1,1,1] row_mask:0xf bank_mask:0xf
    v_add_f32_dpp v53, v34, v53 quad_perm:[2,2,2,2] row_mask:0xf bank_mask:0xf
    v_add_f32_dpp v53, v35, v53 quad_perm:[3,3,3,3] row_mask:0xf bank_mask:0xf
    v_cvt_pk_bf16_f32 v53, 0, v53
    v_mul_f32 v53, 1035273459, v53
    v_cvt_pk_bf16_f32 v46, v52, v53
    s_cbranch_scc1 L_t3_112
    s_waitcnt vmcnt(3)
L_t3_112:
    s_cbranch_vccnz L_t2_113
    s_waitcnt vmcnt(4)
L_t2_113:
    s_waitcnt vmcnt(6)
    buffer_load_dwordx4 v[116:119], v3, s[36:39], s48 offen nt
    v_mfma_f32_16x16x32_bf16 v[32:35], v[88:91], v[16:19], 0
    s_cbranch_scc1 L_t3_114
    s_waitcnt vmcnt(3)
L_t3_114:
    s_cbranch_vccnz L_t2_115
    s_waitcnt vmcnt(4)
L_t2_115:
    s_waitcnt vmcnt(6)
    buffer_load_dwordx4 v[120:123], v4, s[36:39], s48 offen nt
    v_mfma_f32_16x16x32_bf16 v[32:35], v[92:95], v[20:23], v[32:35]
    v_mov_b32_dpp v52, v28 quad_perm:[0,0,0,0] row_mask:0xf bank_mask:0xf
    v_add_f32_dpp v52, v29, v52 quad_perm:[1,1,1,1] row_mask:0xf bank_mask:0xf
    v_add_f32_dpp v52, v30, v52 quad_perm:[2,2,2,2] row_mask:0xf bank_mask:0xf
    v_add_f32_dpp v52, v31, v52 quad_perm:[3,3,3,3] row_mask:0xf bank_mask:0xf
    v_cvt_pk_bf16_f32 v52, 0, v52
    v_mul_f32 v52, 1035273459, v52
    s_cbranch_scc1 L_t3_116
    s_waitcnt vmcnt(3)
L_t3_116:
    s_cbranch_vccnz L_t2_117
    s_waitcnt vmcnt(4)
L_t2_117:
    s_waitcnt vmcnt(6)
    buffer_load_dwordx4 v[124:127], v5, s[36:39], s48 offen nt
    v_mfma_f32_16x16x32_bf16 v[28:31], v[96:99], v[16:19], 0
    s_xor_b32 s48, s94, s49
    s_sub_u32 s94, s94, 1966080
    s_and_b32 s94, s94, 1966080
    s_cmp_eq_u32 s93, 0
    s_cbranch_scc1 L_t3_118
    s_waitcnt vmcnt(3)
L_t3_118:
    s_cbranch_vccnz L_t2_119
    s_waitcnt vmcnt(4)
L_t2_119:
    s_waitcnt vmcnt(6)
    buffer_load_dwordx4 v[64:67], v6, s[40:43], s48 offen nt
    v_mfma_f32_16x16x32_bf16 v[28:31], v[100:103], v[20:23], v[28:31]
    v_mov_b32_dpp v53, v32 quad_perm:[0,0,0,0] row_mask:0xf bank_mask:0xf
    v_add_f32_dpp v53, v33, v53 quad_perm:[1,1,1,1] row_mask:0xf bank_mask:0xf
    v_add_f32_dpp v53, v34, v53 quad_perm:[2,2,2,2] row_mask:0xf bank_mask:0xf
    v_add_f32_dpp v53, v35, v53 quad_perm:[3,3,3,3] row_mask:0xf bank_mask:0xf
    v_cvt_pk_bf16_f32 v53, 0, v53
    v_mul_f32 v53, 1035273459, v53
    v_cvt_pk_bf16_f32 v47, v52, v53
    v_cndmask_b32 v46, v46, v47, s[82:83]
    s_cbranch_scc1 L_t3_120
    s_waitcnt vmcnt(3)
L_t3_120:
    s_cbranch_vccnz L_t2_121
    s_waitcnt vmcnt(4)
L_t2_121:
    s_waitcnt vmcnt(6)
    buffer_load_dwordx4 v[68:71], v7, s[40:43], s48 offen nt
    v_mfma_f32_16x16x32_bf16 v[32:35], v[104:107], v[16:19], 0
    s_cbranch_scc1 L_t3_122
    s_waitcnt vmcnt(3)
L_t3_122:
    s_cbranch_vccnz L_t2_123
    s_waitcnt vmcnt(4)
L_t2_123:
    s_waitcnt vmcnt(6)
    buffer_load_dwordx4 v[72:75], v8, s[40:43], s48 offen nt
    v_mfma_f32_16x16x32_bf16 v[32:35], v[108:111], v[20:23], v[32:35]
    v_mov_b32_dpp v52, v28 quad_perm:[0,0,0,0] row_mask:0xf bank_mask:0xf
    v_add_f32_dpp v52, v29, v52 quad_perm:[1,1,1,1] row_mask:0xf bank_mask:0xf
    v_add_f32_dpp v52, v30, v52 quad_perm:[2,2,2,2] row_mask:0xf bank_mask:0xf
    v_add_f32_dpp v52, v31, v52 quad_perm:[3,3,3,3] row_mask:0xf bank_mask:0xf
    v_cvt_pk_bf16_f32 v52, 0, v52
    v_mul_f32 v52, 1035273459, v52
    s_cbranch_scc1 L_t3_124
    s_waitcnt vmcnt(3)
L_t3_124:
    s_cbranch_vccnz L_t2_125
    s_waitcnt vmcnt(4)
L_t2_125:
    s_waitcnt vmcnt(6)
    buffer_load_dwordx4 v[76:79], v9, s[40:43], s48 offen nt
    v_mfma_f32_16x16x32_bf16 v[28:31], v[112:115], v[16:19], 0
    s_xor_b32 s48, s48, 32768
    s_cmp_eq_u32 s93, 0
    s_cbranch_scc1 L_t3_126
    s_waitcnt vmcnt(3)
L_t3_126:
    s_cbranch_vccnz L_t2_127
    s_waitcnt vmcnt(4)
L_t2_127:
    s_waitcnt vmcnt(6)
    buffer_load_dwordx4 v[80:83], v6, s[40:43], s48 offen nt
    v_mfma_f32_16x16x32_bf16 v[28:31], v[116:119], v[20:23], v[28:31]
    v_mov_b32_dpp v53, v32 quad_perm:[0,0,0,0] row_mask:0xf bank_mask:0xf
    v_add_f32_dpp v53, v33, v53 quad_perm:[1,1,1,1] row_mask:0xf bank_mask:0xf
    v_add_f32_dpp v53, v34, v53 quad_perm:[2,2,2,2] row_mask:0xf bank_mask:0xf
    v_add_f32_dpp v53, v35, v53 quad_perm:[3,3,3,3] row_mask:0xf bank_mask:0xf
    v_cvt_pk_bf16_f32 v53, 0, v53
    v_mul_f32 v53, 1035273459, v53
    v_cvt_pk_bf16_f32 v47, v52, v53
    v_cndmask_b32 v46, v46, v47, s[84:85]
    s_cbranch_scc1 L_t3_128
    s_waitcnt vmcnt(3)
L_t3_128:
    s_cbranch_vccnz L_t2_129
    s_waitcnt vmcnt(4)
L_t2_129:
    s_waitcnt vmcnt(6)
    buffer_load_dwordx4 v[84:87], v7, s[40:43], s48 offen nt
    v_mfma_f32_16x16x32_bf16 v[32:35], v[120:123], v[16:19], 0
    s_cbranch_scc1 L_t3_130
    s_waitcnt vmcnt(3)
L_t3_130:
    s_cbranch_vccnz L_t2_131
    s_waitcnt vmcnt(4)
L_t2_131:
    s_waitcnt vmcnt(6)
    buffer_load_dwordx4 v[88:91], v8, s[40:43], s48 offen nt
    v_mfma_f32_16x16x32_bf16 v[32:35], v[124:127], v[20:23], v[32:35]
    v_mov_b32_dpp v52, v28 quad_perm:[0,0,0,0] row_mask:0xf bank_mask:0xf
    v_add_f32_dpp v52, v29, v52 quad_perm:[1,1,1,1] row_mask:0xf bank_mask:0xf
    v_add_f32_dpp v52, v30, v52 quad_perm:[2,2,2,2] row_mask:0xf bank_mask:0xf
    v_add_f32_dpp v52, v31, v52 quad_perm:[3,3,3,3] row_mask:0xf bank_mask:0xf
    v_cvt_pk_bf16_f32 v52, 0, v52
    v_mul_f32 v52, 1035273459, v52
    s_nop 1
    v_mov_b32_dpp v53, v32 quad_perm:[0,0,0,0] row_mask:0xf bank_mask:0xf
    v_add_f32_dpp v53, v33, v53 quad_perm:[1,1,1,1] row_mask:0xf bank_mask:0xf
    v_add_f32_dpp v53, v34, v53 quad_perm:[2,2,2,2] row_mask:0xf bank_mask:0xf
    v_add_f32_dpp v53, v35, v53 quad_perm:[3,3,3,3] row_mask:0xf bank_mask:0xf
    v_cvt_pk_bf16_f32 v53, 0, v53
    v_mul_f32 v53, 1035273459, v53
    v_cvt_pk_bf16_f32 v47, v52, v53
    v_cndmask_b32 v46, v46, v47, s[86:87]
    ds_write_b32 v1, v46
    v_add_u32 v1, 256, v1
    s_mov_b32 s45, 15
L_vloop:
    s_memrealtime s[58:59]
    s_waitcnt lgkmcnt(0)
    s_lshl_b32 s59, s58, 10
    s_and_b32 s56, s44, 3
    s_cmp_lg_u32 s56, 3
    s_cbranch_scc1 L_c1_132
    s_add_u32 s52, s52, 1
    s_lshr_b32 s57, s52, 27
    s_cmp_lg_u32 s57, 16
    s_cbranch_scc1 L_c1_132
    s_lshl_b32 s52, s52, 6
    s_sub_u32 s57, s59, s52
    s_cmp_ge_u32 s57, 4194304
    s_cbranch_scc1 L_c1_132
    s_sub_u32 s57, s52, s53
    s_mov_b32 s53, s52
    s_lshr_b32 s57, s57, 2
    s_cmp_lt_u32 s57, 326656
    s_cselect_b32 s57, s57, s54
    s_add_u32 s54, s54, s57
    s_lshr_b32 s54, s54, 1
    s_mul_i32 s57, s54, 3
    s_add_u32 s47, s52, s57
L_c1_132:
    s_cmp_lg_u32 s56, 2
    s_cbranch_scc1 L_c2_133
    s_sub_u32 s57, s44, 2
    s_mul_i32 s57, s57, 160
    s_load_dword s52, s[50:51], s57
L_c2_133:
    s_cmp_lg_u32 s56, s55
    s_cbranch_scc1 L_c3_134
    s_and_b32 s58, s58, 0x3fffff
    s_or_b32 s46, s58, 134217728
    s_mul_i32 s57, s44, 160
    s_atomic_add s46, s[50:51], s57
L_c3_134:
    s_sub_u32 s56, s59, s47
    s_add_u32 s47, s47, s54
    s_add_u32 s44, s44, 1
    s_add_u32 s57, s56, 268435456
    s_cmp_lt_u32 s57, 268343296
    s_cselect_b32 s93, 1, 0
    s_cmp_ge_i32 s56, 46080
    s_cselect_b64 vcc, -1, 0
    s_cmp_eq_u32 s93, 0
    v_lshlrev_b32 v52, 16, v54
    v_and_b32 v53, 0xffff0000, v54
    v_add_u32 v55, 256, v55
    v_max_f32 v60, v52, v53
    v_cmp_gt_f32 s[30:31], v60, v61
    ds_read_b32 v54, v55
    s_cmp_eq_u64 s[30:31], 0
    s_cbranch_scc1 L_ct_137
    v_max_f32 v61, v60, v61
    s_nop 1
    v_max_f32_dpp v61, v61, v61 quad_perm:[1,0,3,2] row_mask:0xf bank_mask:0xf
    s_nop 1
    v_max_f32_dpp v61, v61, v61 quad_perm:[2,3,0,1] row_mask:0xf bank_mask:0xf
    s_nop 1
    v_max_f32_dpp v61, v61, v61 row_half_mirror row_mask:0xf bank_mask:0xf
    v_mov_b32 v14, v61
    s_nop 1
    v_permlane16_swap_b32 v61, v14
    v_max_f32 v61, v61, v14
    v_mov_b32 v14, v61
    s_nop 1
    v_permlane32_swap_b32 v61, v14
    v_max_f32 v61, v61, v14
    v_mul_f32 v14, 3216550459, v61
    v_sub_f32 v15, v14, v62
    v_exp_f32 v15, v15
    v_mov_b32 v62, v14
    v_mul_f32 v63, v63, v15
    v_mul_f32 v24, v24, v15
    v_mul_f32 v25, v25, v15
    v_mul_f32 v26, v26, v15
    v_mul_f32 v27, v27, v15
L_ct_137:
    s_cmp_eq_u32 s93, 0
    v_fma_f32 v52, v52, s62, v62
    v_fma_f32 v53, v53, s62, v62
    v_exp_f32 v52, v52
    v_exp_f32 v53, v53
    v_cvt_pk_bf16_f32 v56, v52, v52
    v_cvt_pk_bf16_f32 v57, v53, v53
    v_add_f32 v63, v63, v52
    v_add_f32 v63, v63, v53
    v_mov_b32_dpp v58, v56 row_half_mirror row_mask:0xf bank_mask:0xf
    v_mov_b32_dpp v59, v57 row_half_mirror row_mask:0xf bank_mask:0xf
    v_and_b32_dpp v36, v56, v10 quad_perm:[0,0,0,0] row_mask:0xf bank_mask:0xf
    v_and_b32_dpp v37, v56, v11 quad_perm:[0,0,0,0] row_mask:0xf bank_mask:0xf
    v_and_b32_dpp v38, v58, v12 quad_perm:[3,3,3,3] row_mask:0xf bank_mask:0xf
    v_and_b32_dpp v39, v58, v13 quad_perm:[3,3,3,3] row_mask:0xf bank_mask:0xf
    s_cbranch_scc1 L_t3_138
    s_waitcnt vmcnt(3)
L_t3_138:
    s_cbranch_vccnz L_t2_139
    s_waitcnt vmcnt(4)
L_t2_139:
    s_waitcnt vmcnt(6)
    buffer_load_dwordx4 v[92:95], v9, s[40:43], s48 offen nt
    v_mfma_f32_16x16x32_bf16 v[24:27], v[64:67], v[36:39], v[24:27]
    v_and_b32_dpp v42, v56, v12 quad_perm:[0,0,0,0] row_mask:0xf bank_mask:0xf
    v_and_b32_dpp v43, v56, v13 quad_perm:[0,0,0,0] row_mask:0xf bank_mask:0xf
    v_and_b32_dpp v40, v58, v10 quad_perm:[3,3,3,3] row_mask:0xf bank_mask:0xf
    v_and_b32_dpp v41, v58, v11 quad_perm:[3,3,3,3] row_mask:0xf bank_mask:0xf
    s_xor_b32 s48, s48, 98304
    s_cmp_eq_u32 s93, 0
    s_cbranch_scc1 L_t3_140
    s_waitcnt vmcnt(3)
L_t3_140:
    s_cbranch_vccnz L_t2_141
    s_waitcnt vmcnt(4)
L_t2_141:
    s_waitcnt vmcnt(6)
    buffer_load_dwordx4 v[96:99], v6, s[40:43], s48 offen nt
    v_mfma_f32_16x16x32_bf16 v[24:27], v[68:71], v[40:43], v[24:27]
    v_and_b32_dpp v36, v57, v10 quad_perm:[0,0,0,0] row_mask:0xf bank_mask:0xf
    v_and_b32_dpp v37, v57, v11 quad_perm:[0,0,0,0] row_mask:0xf bank_mask:0xf
    v_and_b32_dpp v38, v59, v12 quad_perm:[3,3,3,3] row_mask:0xf bank_mask:0xf
    v_and_b32_dpp v39, v59, v13 quad_perm:[3,3,3,3] row_mask:0xf bank_mask:0xf
    s_cbranch_scc1 L_t3_142
    s_waitcnt vmcnt(3)
L_t3_142:
    s_cbranch_vccnz L_t2_143
    s_waitcnt vmcnt(4)
L_t2_143:
    s_waitcnt vmcnt(6)
    buffer_load_dwordx4 v[100:103], v7, s[40:43], s48 offen nt
    v_mfma_f32_16x16x32_bf16 v[24:27], v[72:75], v[36:39], v[24:27]
    v_and_b32_dpp v42, v57, v12 quad_perm:[0,0,0,0] row_mask:0xf bank_mask:0xf
    v_and_b32_dpp v43, v57, v13 quad_perm:[0,0,0,0] row_mask:0xf bank_mask:0xf
    v_and_b32_dpp v40, v59, v10 quad_perm:[3,3,3,3] row_mask:0xf bank_mask:0xf
    v_and_b32_dpp v41, v59, v11 quad_perm:[3,3,3,3] row_mask:0xf bank_mask:0xf
    s_cbranch_scc1 L_t3_144
    s_waitcnt vmcnt(3)
L_t3_144:
    s_cbranch_vccnz L_t2_145
    s_waitcnt vmcnt(4)
L_t2_145:
    s_waitcnt vmcnt(6)
    buffer_load_dwordx4 v[104:107], v8, s[40:43], s48 offen nt
    v_mfma_f32_16x16x32_bf16 v[24:27], v[76:79], v[40:43], v[24:27]
    v_and_b32_dpp v36, v56, v10 quad_perm:[1,1,1,1] row_mask:0xf bank_mask:0xf
    v_and_b32_dpp v37, v56, v11 quad_perm:[1,1,1,1] row_mask:0xf bank_mask:0xf
    v_and_b32_dpp v38, v58, v12 quad_perm:[2,2,2,2] row_mask:0xf bank_mask:0xf
    v_and_b32_dpp v39, v58, v13 quad_perm:[2,2,2,2] row_mask:0xf bank_mask:0xf
    s_cbranch_scc1 L_t3_146
    s_waitcnt vmcnt(3)
L_t3_146:
    s_cbranch_vccnz L_t2_147
    s_waitcnt vmcnt(4)
L_t2_147:
    s_waitcnt vmcnt(6)
    buffer_load_dwordx4 v[108:111], v9, s[40:43], s48 offen nt
    v_mfma_f32_16x16x32_bf16 v[24:27], v[80:83], v[36:39], v[24:27]
    v_and_b32_dpp v42, v56, v12 quad_perm:[1,1,1,1] row_mask:0xf bank_mask:0xf
    v_and_b32_dpp v43, v56, v13 quad_perm:[1,1,1,1] row_mask:0xf bank_mask:0xf
    v_and_b32_dpp v40, v58, v10 quad_perm:[2,2,2,2] row_mask:0xf bank_mask:0xf
    v_and_b32_dpp v41, v58, v11 quad_perm:[2,2,2,2] row_mask:0xf bank_mask:0xf
    s_xor_b32 s48, s48, 32768
    s_cmp_eq_u32 s93, 0
    s_cbranch_scc1 L_t3_148
    s_waitcnt vmcnt(3)
L_t3_148:
    s_cbranch_vccnz L_t2_149
    s_waitcnt vmcnt(4)
L_t2_149:
    s_waitcnt vmcnt(6)
    buffer_load_dwordx4 v[112:115], v6, s[40:43], s48 offen nt
    v_mfma_f32_16x16x32_bf16 v[24:27], v[84:87], v[40:43], v[24:27]
    v_and_b32_dpp v36, v57, v10 quad_perm:[1,1,1,1] row_mask:0xf bank_mask:0xf
    v_and_b32_dpp v37, v57, v11 quad_perm:[1,1,1,1] row_mask:0xf bank_mask:0xf
    v_and_b32_dpp v38, v59, v12 quad_perm:[2,2,2,2] row_mask:0xf bank_mask:0xf
    v_and_b32_dpp v39, v59, v13 quad_perm:[2,2,2,2] row_mask:0xf bank_mask:0xf
    s_cbranch_scc1 L_t3_150
    s_waitcnt vmcnt(3)
L_t3_150:
    s_cbranch_vccnz L_t2_151
    s_waitcnt vmcnt(4)
L_t2_151:
    s_waitcnt vmcnt(6)
    buffer_load_dwordx4 v[116:119], v7, s[40:43], s48 offen nt
    v_mfma_f32_16x16x32_bf16 v[24:27], v[88:91], v[36:39], v[24:27]
    v_and_b32_dpp v42, v57, v12 quad_perm:[1,1,1,1] row_mask:0xf bank_mask:0xf
    v_and_b32_dpp v43, v57, v13 quad_perm:[1,1,1,1] row_mask:0xf bank_mask:0xf
    v_and_b32_dpp v40, v59, v10 quad_perm:[2,2,2,2] row_mask:0xf bank_mask:0xf
    v_and_b32_dpp v41, v59, v11 quad_perm:[2,2,2,2] row_mask:0xf bank_mask:0xf
    s_cbranch_scc1 L_t3_152
    s_waitcnt vmcnt(3)
L_t3_152:
    s_cbranch_vccnz L_t2_153
    s_waitcnt vmcnt(4)
L_t2_153:
    s_waitcnt vmcnt(6)
    buffer_load_dwordx4 v[120:123], v8, s[40:43], s48 offen nt
    v_mfma_f32_16x16x32_bf16 v[24:27], v[92:95], v[40:43], v[24:27]
    v_and_b32_dpp v36, v56, v10 quad_perm:[2,2,2,2] row_mask:0xf bank_mask:0xf
    v_and_b32_dpp v37, v56, v11 quad_perm:[2,2,2,2] row_mask:0xf bank_mask:0xf
    v_and_b32_dpp v38, v58, v12 quad_perm:[1,1,1,1] row_mask:0xf bank_mask:0xf
    v_and_b32_dpp v39, v58, v13 quad_perm:[1,1,1,1] row_mask:0xf bank_mask:0xf
    s_cbranch_scc1 L_t3_154
    s_waitcnt vmcnt(3)
L_t3_154:
    s_cbranch_vccnz L_t2_155
    s_waitcnt vmcnt(4)
L_t2_155:
    s_waitcnt vmcnt(6)
    buffer_load_dwordx4 v[124:127], v9, s[40:43], s48 offen nt
    v_mfma_f32_16x16x32_bf16 v[24:27], v[96:99], v[36:39], v[24:27]
    v_and_b32_dpp v42, v56, v12 quad_perm:[2,2,2,2] row_mask:0xf bank_mask:0xf
    v_and_b32_dpp v43, v56, v13 quad_perm:[2,2,2,2] row_mask:0xf bank_mask:0xf
    v_and_b32_dpp v40, v58, v10 quad_perm:[1,1,1,1] row_mask:0xf bank_mask:0xf
    v_and_b32_dpp v41, v58, v11 quad_perm:[1,1,1,1] row_mask:0xf bank_mask:0xf
    s_xor_b32 s48, s94, s49
    s_sub_u32 s94, s94, 1966080
    s_and_b32 s94, s94, 1966080
    s_cmp_eq_u32 s93, 0
    s_cbranch_scc1 L_t3_156
    s_waitcnt vmcnt(3)
L_t3_156:
    s_cbranch_vccnz L_t2_157
    s_waitcnt vmcnt(4)
L_t2_157:
    s_waitcnt vmcnt(6)
    buffer_load_dwordx4 v[64:67], v6, s[40:43], s48 offen nt
    v_mfma_f32_16x16x32_bf16 v[24:27], v[100:103], v[40:43], v[24:27]
    v_and_b32_dpp v36, v57, v10 quad_perm:[2,2,2,2] row_mask:0xf bank_mask:0xf
    v_and_b32_dpp v37, v57, v11 quad_perm:[2,2,2,2] row_mask:0xf bank_mask:0xf
    v_and_b32_dpp v38, v59, v12 quad_perm:[1,1,1,1] row_mask:0xf bank_mask:0xf
    v_and_b32_dpp v39, v59, v13 quad_perm:[1,1,1,1] row_mask:0xf bank_mask:0xf
    s_cbranch_scc1 L_t3_158
    s_waitcnt vmcnt(3)
L_t3_158:
    s_cbranch_vccnz L_t2_159
    s_waitcnt vmcnt(4)
L_t2_159:
    s_waitcnt vmcnt(6)
    buffer_load_dwordx4 v[68:71], v7, s[40:43], s48 offen nt
    v_mfma_f32_16x16x32_bf16 v[24:27], v[104:107], v[36:39], v[24:27]
    v_and_b32_dpp v42, v57, v12 quad_perm:[2,2,2,2] row_mask:0xf bank_mask:0xf
    v_and_b32_dpp v43, v57, v13 quad_perm:[2,2,2,2] row_mask:0xf bank_mask:0xf
    v_and_b32_dpp v40, v59, v10 quad_perm:[1,1,1,1] row_mask:0xf bank_mask:0xf
    v_and_b32_dpp v41, v59, v11 quad_perm:[1,1,1,1] row_mask:0xf bank_mask:0xf
    s_cbranch_scc1 L_t3_160
    s_waitcnt vmcnt(3)
L_t3_160:
    s_cbranch_vccnz L_t2_161
    s_waitcnt vmcnt(4)
L_t2_161:
    s_waitcnt vmcnt(6)
    buffer_load_dwordx4 v[72:75], v8, s[40:43], s48 offen nt
    v_mfma_f32_16x16x32_bf16 v[24:27], v[108:111], v[40:43], v[24:27]
    v_and_b32_dpp v36, v56, v10 quad_perm:[3,3,3,3] row_mask:0xf bank_mask:0xf
    v_and_b32_dpp v37, v56, v11 quad_perm:[3,3,3,3] row_mask:0xf bank_mask:0xf
    v_and_b32_dpp v38, v58, v12 quad_perm:[0,0,0,0] row_mask:0xf bank_mask:0xf
    v_and_b32_dpp v39, v58, v13 quad_perm:[0,0,0,0] row_mask:0xf bank_mask:0xf
    s_cbranch_scc1 L_t3_162
    s_waitcnt vmcnt(3)
L_t3_162:
    s_cbranch_vccnz L_t2_163
    s_waitcnt vmcnt(4)
L_t2_163:
    s_waitcnt vmcnt(6)
    buffer_load_dwordx4 v[76:79], v9, s[40:43], s48 offen nt
    v_mfma_f32_16x16x32_bf16 v[24:27], v[112:115], v[36:39], v[24:27]
    v_and_b32_dpp v42, v56, v12 quad_perm:[3,3,3,3] row_mask:0xf bank_mask:0xf
    v_and_b32_dpp v43, v56, v13 quad_perm:[3,3,3,3] row_mask:0xf bank_mask:0xf
    v_and_b32_dpp v40, v58, v10 quad_perm:[0,0,0,0] row_mask:0xf bank_mask:0xf
    v_and_b32_dpp v41, v58, v11 quad_perm:[0,0,0,0] row_mask:0xf bank_mask:0xf
    s_xor_b32 s48, s48, 32768
    s_cmp_eq_u32 s93, 0
    s_cbranch_scc1 L_t3_164
    s_waitcnt vmcnt(3)
L_t3_164:
    s_cbranch_vccnz L_t2_165
    s_waitcnt vmcnt(4)
L_t2_165:
    s_waitcnt vmcnt(6)
    buffer_load_dwordx4 v[80:83], v6, s[40:43], s48 offen nt
    v_mfma_f32_16x16x32_bf16 v[24:27], v[116:119], v[40:43], v[24:27]
    v_and_b32_dpp v36, v57, v10 quad_perm:[3,3,3,3] row_mask:0xf bank_mask:0xf
    v_and_b32_dpp v37, v57, v11 quad_perm:[3,3,3,3] row_mask:0xf bank_mask:0xf
    v_and_b32_dpp v38, v59, v12 quad_perm:[0,0,0,0] row_mask:0xf bank_mask:0xf
    v_and_b32_dpp v39, v59, v13 quad_perm:[0,0,0,0] row_mask:0xf bank_mask:0xf
    s_cbranch_scc1 L_t3_166
    s_waitcnt vmcnt(3)
L_t3_166:
    s_cbranch_vccnz L_t2_167
    s_waitcnt vmcnt(4)
L_t2_167:
    s_waitcnt vmcnt(6)
    buffer_load_dwordx4 v[84:87], v7, s[40:43], s48 offen nt
    v_mfma_f32_16x16x32_bf16 v[24:27], v[120:123], v[36:39], v[24:27]
    v_and_b32_dpp v42, v57, v12 quad_perm:[3,3,3,3] row_mask:0xf bank_mask:0xf
    v_and_b32_dpp v43, v57, v13 quad_perm:[3,3,3,3] row_mask:0xf bank_mask:0xf
    v_and_b32_dpp v40, v59, v10 quad_perm:[0,0,0,0] row_mask:0xf bank_mask:0xf
    v_and_b32_dpp v41, v59, v11 quad_perm:[0,0,0,0] row_mask:0xf bank_mask:0xf
    s_cbranch_scc1 L_t3_168
    s_waitcnt vmcnt(3)
L_t3_168:
    s_cbranch_vccnz L_t2_169
    s_waitcnt vmcnt(4)
L_t2_169:
    s_waitcnt vmcnt(6)
    buffer_load_dwordx4 v[88:91], v8, s[40:43], s48 offen nt
    v_mfma_f32_16x16x32_bf16 v[24:27], v[124:127], v[40:43], v[24:27]
    s_sub_u32 s45, s45, 1
    s_cmp_lg_u32 s45, 0
    s_cbranch_scc1 L_vloop
L_last_0:
    s_waitcnt lgkmcnt(0)
    v_lshlrev_b32 v52, 16, v54
    v_and_b32 v53, 0xffff0000, v54
    v_add_u32 v55, 256, v55
    v_max_f32 v60, v52, v53
    v_cmp_gt_f32 s[30:31], v60, v61
    ds_read_b32 v54, v55
    s_cmp_eq_u64 s[30:31], 0
    s_cbranch_scc1 L_ct_171
    v_max_f32 v61, v60, v61
    s_nop 1
    v_max_f32_dpp v61, v61, v61 quad_perm:[1,0,3,2] row_mask:0xf bank_mask:0xf
    s_nop 1
    v_max_f32_dpp v61, v61, v61 quad_perm:[2,3,0,1] row_mask:0xf bank_mask:0xf
    s_nop 1
    v_max_f32_dpp v61, v61, v61 row_half_mirror row_mask:0xf bank_mask:0xf
    v_mov_b32 v14, v61
    s_nop 1
    v_permlane16_swap_b32 v61, v14
    v_max_f32 v61, v61, v14
    v_mov_b32 v14, v61
    s_nop 1
    v_permlane32_swap_b32 v61, v14
    v_max_f32 v61, v61, v14
    v_mul_f32 v14, 3216550459, v61
    v_sub_f32 v15, v14, v62
    v_exp_f32 v15, v15
    v_mov_b32 v62, v14
    v_mul_f32 v63, v63, v15
    v_mul_f32 v24, v24, v15
    v_mul_f32 v25, v25, v15
    v_mul_f32 v26, v26, v15
    v_mul_f32 v27, v27, v15
L_ct_171:
    v_fma_f32 v52, v52, s62, v62
    v_fma_f32 v53, v53, s62, v62
    v_exp_f32 v52, v52
    v_exp_f32 v53, v53
    v_cvt_pk_bf16_f32 v56, v52, v52
    v_cvt_pk_bf16_f32 v57, v53, v53
    v_add_f32 v63, v63, v52
    v_add_f32 v63, v63, v53
    v_mov_b32_dpp v58, v56 row_half_mirror row_mask:0xf bank_mask:0xf
    v_mov_b32_dpp v59, v57 row_half_mirror row_mask:0xf bank_mask:0xf
    s_lshl_b32 s57, s3, 10
    v_lshl_add_u32 v14, v0, 4, s57
    v_lshrrev_b32 v15, 1, v14
    ds_write_b64 v15, v[62:63] offset:6656
    v_and_b32_dpp v36, v56, v10 quad_perm:[0,0,0,0] row_mask:0xf bank_mask:0xf
    v_and_b32_dpp v37, v56, v11 quad_perm:[0,0,0,0] row_mask:0xf bank_mask:0xf
    v_and_b32_dpp v38, v58, v12 quad_perm:[3,3,3,3] row_mask:0xf bank_mask:0xf
    v_and_b32_dpp v39, v58, v13 quad_perm:[3,3,3,3] row_mask:0xf bank_mask:0xf
    s_waitcnt vmcnt(6)
    buffer_load_dwordx4 v[92:95], v9, s[40:43], s48 offen nt
    v_mfma_f32_16x16x32_bf16 v[24:27], v[64:67], v[36:39], v[24:27]
    v_and_b32_dpp v42, v56, v12 quad_perm:[0,0,0,0] row_mask:0xf bank_mask:0xf
    v_and_b32_dpp v43, v56, v13 quad_perm:[0,0,0,0] row_mask:0xf bank_mask:0xf
    v_and_b32_dpp v40, v58, v10 quad_perm:[3,3,3,3] row_mask:0xf bank_mask:0xf
    v_and_b32_dpp v41, v58, v11 quad_perm:[3,3,3,3] row_mask:0xf bank_mask:0xf
    s_xor_b32 s48, s48, 98304
    s_waitcnt vmcnt(6)
    buffer_load_dwordx4 v[96:99], v6, s[40:43], s48 offen nt
    v_mfma_f32_16x16x32_bf16 v[24:27], v[68:71], v[40:43], v[24:27]
    v_and_b32_dpp v36, v57, v10 quad_perm:[0,0,0,0] row_mask:0xf bank_mask:0xf
    v_and_b32_dpp v37, v57, v11 quad_perm:[0,0,0,0] row_mask:0xf bank_mask:0xf
    v_and_b32_dpp v38, v59, v12 quad_perm:[3,3,3,3] row_mask:0xf bank_mask:0xf
    v_and_b32_dpp v39, v59, v13 quad_perm:[3,3,3,3] row_mask:0xf bank_mask:0xf
    s_waitcnt vmcnt(6)
    buffer_load_dwordx4 v[100:103], v7, s[40:43], s48 offen nt
    s_waitcnt lgkmcnt(0)
    s_barrier
    v_mfma_f32_16x16x32_bf16 v[24:27], v[72:75], v[36:39], v[24:27]
    v_and_b32_dpp v42, v57, v12 quad_perm:[0,0,0,0] row_mask:0xf bank_mask:0xf
    v_and_b32_dpp v43, v57, v13 quad_perm:[0,0,0,0] row_mask:0xf bank_mask:0xf
    v_and_b32_dpp v40, v59, v10 quad_perm:[3,3,3,3] row_mask:0xf bank_mask:0xf
    v_and_b32_dpp v41, v59, v11 quad_perm:[3,3,3,3] row_mask:0xf bank_mask:0xf
    s_waitcnt vmcnt(6)
    buffer_load_dwordx4 v[104:107], v8, s[40:43], s48 offen nt
    v_mfma_f32_16x16x32_bf16 v[24:27], v[76:79], v[40:43], v[24:27]
    v_and_b32_dpp v36, v56, v10 quad_perm:[1,1,1,1] row_mask:0xf bank_mask:0xf
    v_and_b32_dpp v37, v56, v11 quad_perm:[1,1,1,1] row_mask:0xf bank_mask:0xf
    v_and_b32_dpp v38, v58, v12 quad_perm:[2,2,2,2] row_mask:0xf bank_mask:0xf
    v_and_b32_dpp v39, v58, v13 quad_perm:[2,2,2,2] row_mask:0xf bank_mask:0xf
    s_waitcnt vmcnt(6)
    buffer_load_dwordx4 v[108:111], v9, s[40:43], s48 offen nt
    v_mfma_f32_16x16x32_bf16 v[24:27], v[80:83], v[36:39], v[24:27]
    v_and_b32_dpp v42, v56, v12 quad_perm:[1,1,1,1] row_mask:0xf bank_mask:0xf
    v_and_b32_dpp v43, v56, v13 quad_perm:[1,1,1,1] row_mask:0xf bank_mask:0xf
    v_and_b32_dpp v40, v58, v10 quad_perm:[2,2,2,2] row_mask:0xf bank_mask:0xf
    v_and_b32_dpp v41, v58, v11 quad_perm:[2,2,2,2] row_mask:0xf bank_mask:0xf
    s_xor_b32 s48, s48, 32768
    s_waitcnt vmcnt(6)
    buffer_load_dwordx4 v[112:115], v6, s[40:43], s48 offen nt
    v_mfma_f32_16x16x32_bf16 v[24:27], v[84:87], v[40:43], v[24:27]
    v_and_b32_dpp v36, v57, v10 quad_perm:[1,1,1,1] row_mask:0xf bank_mask:0xf
    v_and_b32_dpp v37, v57, v11 quad_perm:[1,1,1,1] row_mask:0xf bank_mask:0xf
    v_and_b32_dpp v38, v59, v12 quad_perm:[2,2,2,2] row_mask:0xf bank_mask:0xf
    v_and_b32_dpp v39, v59, v13 quad_perm:[2,2,2,2] row_mask:0xf bank_mask:0xf
    s_waitcnt vmcnt(6)
    buffer_load_dwordx4 v[116:119], v7, s[40:43], s48 offen nt
    v_mfma_f32_16x16x32_bf16 v[24:27], v[88:91], v[36:39], v[24:27]
    v_and_b32_dpp v42, v57, v12 quad_perm:[1,1,1,1] row_mask:0xf bank_mask:0xf
    v_and_b32_dpp v43, v57, v13 quad_perm:[1,1,1,1] row_mask:0xf bank_mask:0xf
    v_and_b32_dpp v40, v59, v10 quad_perm:[2,2,2,2] row_mask:0xf bank_mask:0xf
    v_and_b32_dpp v41, v59, v11 quad_perm:[2,2,2,2] row_mask:0xf bank_mask:0xf
    s_waitcnt vmcnt(6)
    buffer_load_dwordx4 v[120:123], v8, s[40:43], s48 offen nt
    v_mfma_f32_16x16x32_bf16 v[24:27], v[92:95], v[40:43], v[24:27]
    v_and_b32_dpp v36, v56, v10 quad_perm:[2,2,2,2] row_mask:0xf bank_mask:0xf
    v_and_b32_dpp v37, v56, v11 quad_perm:[2,2,2,2] row_mask:0xf bank_mask:0xf
    v_and_b32_dpp v38, v58, v12 quad_perm:[1,1,1,1] row_mask:0xf bank_mask:0xf
    v_and_b32_dpp v39, v58, v13 quad_perm:[1,1,1,1] row_mask:0xf bank_mask:0xf
    s_waitcnt vmcnt(6)
    buffer_load_dwordx4 v[124:127], v9, s[40:43], s48 offen nt
    v_mfma_f32_16x16x32_bf16 v[24:27], v[96:99], v[36:39], v[24:27]
    v_and_b32_dpp v42, v56, v12 quad_perm:[2,2,2,2] row_mask:0xf bank_mask:0xf
    v_and_b32_dpp v43, v56, v13 quad_perm:[2,2,2,2] row_mask:0xf bank_mask:0xf
    v_and_b32_dpp v40, v58, v10 quad_perm:[1,1,1,1] row_mask:0xf bank_mask:0xf
    v_and_b32_dpp v41, v58, v11 quad_perm:[1,1,1,1] row_mask:0xf bank_mask:0xf
    s_waitcnt vmcnt(6)
    s_nop 0
    v_mfma_f32_16x16x32_bf16 v[24:27], v[100:103], v[40:43], v[24:27]
    v_and_b32_dpp v36, v57, v10 quad_perm:[2,2,2,2] row_mask:0xf bank_mask:0xf
    v_and_b32_dpp v37, v57, v11 quad_perm:[2,2,2,2] row_mask:0xf bank_mask:0xf
    v_and_b32_dpp v38, v59, v12 quad_perm:[1,1,1,1] row_mask:0xf bank_mask:0xf
    v_and_b32_dpp v39, v59, v13 quad_perm:[1,1,1,1] row_mask:0xf bank_mask:0xf
    s_waitcnt vmcnt(5)
    s_nop 0
    v_mfma_f32_16x16x32_bf16 v[24:27], v[104:107], v[36:39], v[24:27]
    v_and_b32_dpp v42, v57, v12 quad_perm:[2,2,2,2] row_mask:0xf bank_mask:0xf
    v_and_b32_dpp v43, v57, v13 quad_perm:[2,2,2,2] row_mask:0xf bank_mask:0xf
    v_and_b32_dpp v40, v59, v10 quad_perm:[1,1,1,1] row_mask:0xf bank_mask:0xf
    v_and_b32_dpp v41, v59, v11 quad_perm:[1,1,1,1] row_mask:0xf bank_mask:0xf
    s_waitcnt vmcnt(4)
    s_nop 0
    v_mfma_f32_16x16x32_bf16 v[24:27], v[108:111], v[40:43], v[24:27]
    v_and_b32_dpp v36, v56, v10 quad_perm:[3,3,3,3] row_mask:0xf bank_mask:0xf
    v_and_b32_dpp v37, v56, v11 quad_perm:[3,3,3,3] row_mask:0xf bank_mask:0xf
    v_and_b32_dpp v38, v58, v12 quad_perm:[0,0,0,0] row_mask:0xf bank_mask:0xf
    v_and_b32_dpp v39, v58, v13 quad_perm:[0,0,0,0] row_mask:0xf bank_mask:0xf
    s_waitcnt vmcnt(3)
    s_nop 0
    v_mfma_f32_16x16x32_bf16 v[24:27], v[112:115], v[36:39], v[24:27]
    v_and_b32_dpp v42, v56, v12 quad_perm:[3,3,3,3] row_mask:0xf bank_mask:0xf
    v_and_b32_dpp v43, v56, v13 quad_perm:[3,3,3,3] row_mask:0xf bank_mask:0xf
    v_and_b32_dpp v40, v58, v10 quad_perm:[0,0,0,0] row_mask:0xf bank_mask:0xf
    v_and_b32_dpp v41, v58, v11 quad_perm:[0,0,0,0] row_mask:0xf bank_mask:0xf
    s_waitcnt vmcnt(2)
    s_nop 0
    v_mfma_f32_16x16x32_bf16 v[24:27], v[116:119], v[40:43], v[24:27]
    v_and_b32_dpp v36, v57, v10 quad_perm:[3,3,3,3] row_mask:0xf bank_mask:0xf
    v_and_b32_dpp v37, v57, v11 quad_perm:[3,3,3,3] row_mask:0xf bank_mask:0xf
    v_and_b32_dpp v38, v59, v12 quad_perm:[0,0,0,0] row_mask:0xf bank_mask:0xf
    v_and_b32_dpp v39, v59, v13 quad_perm:[0,0,0,0] row_mask:0xf bank_mask:0xf
    s_waitcnt vmcnt(1)
    s_nop 0
    v_mfma_f32_16x16x32_bf16 v[24:27], v[120:123], v[36:39], v[24:27]
    v_and_b32_dpp v42, v57, v12 quad_perm:[3,3,3,3] row_mask:0xf bank_mask:0xf
    v_and_b32_dpp v43, v57, v13 quad_perm:[3,3,3,3] row_mask:0xf bank_mask:0xf
    v_and_b32_dpp v40, v59, v10 quad_perm:[0,0,0,0] row_mask:0xf bank_mask:0xf
    v_and_b32_dpp v41, v59, v11 quad_perm:[0,0,0,0] row_mask:0xf bank_mask:0xf
    s_waitcnt vmcnt(0)
    s_nop 0
    v_mfma_f32_16x16x32_bf16 v[24:27], v[124:127], v[40:43], v[24:27]
L_sdone:
    s_nop 7
    ds_write_b128 v14, v[24:27] offset:2176
    s_waitcnt lgkmcnt(0)
    s_barrier
L_wend:
    s_endpgm
L_helper:
    s_setprio 3
    s_sub_u32 s3, s3, 4
    s_lshl_b32 s99, s97, 5
    s_or_b32 s99, s99, s98
    v_lshlrev_b32 v2, 1, v0
    s_waitcnt lgkmcnt(0)
    s_load_dword s60, s[28:29], 0
    s_mov_b32 s32, s28
    s_mov_b32 s33, s29
    s_mov_b32 s34, 2097152
    s_mov_b32 s35, 0x20000
    s_cmp_lg_u32 s3, 3
    s_cbranch_scc1 L_h012
    s_cmp_lt_u32 s2, 54
    s_cbranch_scc0 L_h1
    s_mul_i32 s49, s2, 3641
    s_lshr_b32 s49, s49, 16
    s_mul_i32 s48, s49, 18
    s_sub_u32 s48, s2, s48
    s_mul_i32 s52, s2, 640
    s_add_u32 s52, s52, 204800
    s_cmp_lt_u32 s2, 8
    s_cselect_b32 s52, s52, 2097152
    s_mov_b32 s53, 512
L_h0j:
    s_mov_b32 s36, s20
    s_mov_b32 s37, s21
    s_mov_b32 s38, 1152
    s_mov_b32 s39, 0x20000
    s_mov_b32 s40, s22
    s_mov_b32 s41, s23
    s_mov_b32 s42, 3981312
    s_mov_b32 s43, 0x20000
    s_mul_i32 s50, s49, 384
    v_mov_b32 v160, 0
    v_mov_b32 v161, 0
    v_mov_b32 v162, 0
    buffer_load_short_d16_hi v160, v2, s[36:39], s50 offen offset:0
    buffer_load_short_d16_hi v161, v2, s[36:39], s50 offen offset:128
    buffer_load_short_d16_hi v162, v2, s[36:39], s50 offen offset:256
    s_mul_i32 s51, s49, 1327104
    s_lshl_b32 s50, s48, 7
    s_add_u32 s51, s51, s50
    v_mul_u32_u24 v4, 48, v1
    v_bfe_u32 v44, v0, 3, 1
    v_add_u32 v4, v4, v44
    v_mul_u32_u24 v4, 6912, v4
    v_and_b32 v44, 7, v0
    v_lshl_add_u32 v4, v44, 4, v4
    buffer_load_dwordx4 v[64:67], v4, s[40:43], s51 offen nt
    s_add_u32 s51, s51, 13824
    buffer_load_dwordx4 v[68:71], v4, s[40:43], s51 offen nt
    s_add_u32 s51, s51, 13824
    buffer_load_dwordx4 v[72:75], v4, s[40:43], s51 offen nt
    s_add_u32 s51, s51, 13824
    buffer_load_dwordx4 v[76:79], v4, s[40:43], s51 offen nt
    s_add_u32 s51, s51, 13824
    buffer_load_dwordx4 v[80:83], v4, s[40:43], s51 offen nt
    s_add_u32 s51, s51, 13824
    buffer_load_dwordx4 v[84:87], v4, s[40:43], s51 offen nt
    s_add_u32 s51, s51, 13824
    buffer_load_dwordx4 v[88:91], v4, s[40:43], s51 offen nt
    s_add_u32 s51, s51, 13824
    buffer_load_dwordx4 v[92:95], v4, s[40:43], s51 offen nt
    s_add_u32 s51, s51, 13824
    buffer_load_dwordx4 v[96:99], v4, s[40:43], s51 offen nt
    s_add_u32 s51, s51, 13824
    buffer_load_dwordx4 v[100:103], v4, s[40:43], s51 offen nt
    s_add_u32 s51, s51, 13824
    buffer_load_dwordx4 v[104:107], v4, s[40:43], s51 offen nt
    s_add_u32 s51, s51, 13824
    buffer_load_dwordx4 v[108:111], v4, s[40:43], s51 offen nt
    s_add_u32 s51, s51, 13824
    buffer_load_dwordx4 v[112:115], v4, s[40:43], s51 offen nt
    s_add_u32 s51, s51, 13824
    buffer_load_dwordx4 v[116:119], v4, s[40:43], s51 offen nt
    s_add_u32 s51, s51, 13824
    buffer_load_dwordx4 v[120:123], v4, s[40:43], s51 offen nt
    s_add_u32 s51, s51, 13824
    buffer_load_dwordx4 v[124:127], v4, s[40:43], s51 offen nt
    s_add_u32 s51, s51, 13824
    buffer_load_dwordx4 v[128:131], v4, s[40:43], s51 offen nt
    s_add_u32 s51, s51, 13824
    buffer_load_dwordx4 v[132:135], v4, s[40:43], s51 offen nt
    s_add_u32 s51, s51, 13824
    buffer_load_dwordx4 v[136:139], v4, s[40:43], s51 offen nt
    s_add_u32 s51, s51, 13824
    buffer_load_dwordx4 v[140:143], v4, s[40:43], s51 offen nt
    s_add_u32 s51, s51, 13824
    buffer_load_dwordx4 v[144:147], v4, s[40:43], s51 offen nt
    s_add_u32 s51, s51, 13824
    buffer_load_dwordx4 v[148:151], v4, s[40:43], s51 offen nt
    s_add_u32 s51, s51, 13824
    buffer_load_dwordx4 v[152:155], v4, s[40:43], s51 offen nt
    s_add_u32 s51, s51, 13824
    buffer_load_dwordx4 v[156:159], v4, s[40:43], s51 offen nt
    s_cmp_lg_u32 s3, 3
    s_cbranch_scc1 L_h0i
    s_barrier
L_h0i:
    v_mov_b32 v216, -1
    s_mov_b64 exec, 1
    buffer_store_dword v216, v2, s[32:35], s52 offen sc1
    s_mov_b64 exec, -1
    v_bfe_u32 v44, v0, 3, 1
    v_mul_u32_u24 v44, 0x0202, v44
    v_add_u32 v44, 0x0100, v44
    v_or_b32 v45, 0x0c0c0000, v44
    v_lshlrev_b32 v44, 16, v44
    v_or_b32 v44, 0x0c0c, v44
    v_and_b32 v46, 1, v0
    v_cmp_eq_u32 vcc, 1, v46
    s_nop 1
    v_cndmask_b32 v44, v45, v44, vcc
    v_bfe_u32 v46, v0, 1, 2
    v_mov_b32 v45, 0x0c0c0c0c
    v_cmp_eq_u32 vcc, 0, v46
    s_nop 1
    v_cndmask_b32 v8, v45, v44, vcc
    v_cmp_eq_u32 vcc, 1, v46
    s_nop 1
    v_cndmask_b32 v9, v45, v44, vcc
    v_cmp_eq_u32 vcc, 2, v46
    s_nop 1
    v_cndmask_b32 v10, v45, v44, vcc
    v_cmp_eq_u32 vcc, 3, v46
    s_nop 1
    v_cndmask_b32 v11, v45, v44, vcc
    v_and_b32 v5, 1, v1
    v_lshlrev_b32 v5, 8, v5
    v_and_b32 v44, 7, v0
    v_lshl_add_u32 v5, v44, 4, v5
    v_lshrrev_b32 v44, 5, v0
    v_lshl_add_u32 v5, v44, 7, v5
    v_mul_u32_u24 v3, 96, v1
    s_mul_i32 s50, s49, 54
    s_add_u32 s50, s50, s48
    s_lshl_b32 s50, s50, 9
    s_add_u32 s50, s50, 16384
    s_waitcnt vmcnt(25)
    s_cmp_lg_u32 s3, 3
    s_cbranch_scc1 L_h0k
    s_waitcnt lgkmcnt(0)
    s_mul_i32 s60, s60, 1664525
    s_add_u32 s60, s60, 1013904223
L_h0k:
    v_add_u32 v2, s53, v2
    v_add_u32 v3, s53, v3
    v_mul_f32 v164, 3216550459, v160
    v_mul_f32 v165, 3216550459, v161
    v_mul_f32 v166, 3216550459, v162
    v_exp_f32 v164, v164
    v_exp_f32 v165, v165
    v_exp_f32 v166, v166
    v_add_f32 v164, 1.0, v164
    v_add_f32 v165, 1.0, v165
    v_add_f32 v166, 1.0, v166
    v_rcp_f32 v168, v164
    v_rcp_f32 v169, v165
    v_rcp_f32 v170, v166
    v_mul_f32 v172, v160, v168
    v_mul_f32 v173, v161, v169
    v_mul_f32 v174, v162, v170
    v_fma_f32 v176, -v172, v164, v160
    v_fma_f32 v177, -v173, v165, v161
    v_fma_f32 v178, -v174, v166, v162
    v_fma_f32 v172, v176, v168, v172
    v_fma_f32 v173, v177, v169, v173
    v_fma_f32 v174, v178, v170, v174
    v_div_fixup_f32 v160, v172, v164, v160
    v_div_fixup_f32 v161, v173, v165, v161
    v_div_fixup_f32 v162, v174, v166, v162
    v_cvt_pk_bf16_f32 v160, 0, v160
    v_cvt_pk_bf16_f32 v161, 0, v161
    v_cvt_pk_bf16_f32 v162, 0, v162
    ds_write_b16_d16_hi v2, v160 offset:0
    ds_write_b16_d16_hi v2, v161 offset:128
    ds_write_b16_d16_hi v2, v162 offset:256
    ds_read_b128 v[12:15], v3 offset:0
    ds_read_b128 v[16:19], v3 offset:16
    ds_read_b128 v[20:23], v3 offset:32
    ds_read_b128 v[24:27], v3 offset:48
    ds_read_b128 v[28:31], v3 offset:64
    ds_read_b128 v[32:35], v3 offset:80
    s_waitcnt lgkmcnt(5)
    v_perm_b32 v36, v12, v12, v8
    v_perm_b32 v37, v12, v12, v9
    v_perm_b32 v38, v12, v12, v10
    v_perm_b32 v39, v12, v12, v11
    v_perm_b32 v40, v13, v13, v8
    v_perm_b32 v41, v13, v13, v9
    v_perm_b32 v42, v13, v13, v10
    v_perm_b32 v43, v13, v13, v11
    s_waitcnt vmcnt(24)
    v_mfma_f32_16x16x32_bf16 v[208:211], v[64:67], v[36:39], 0
    v_perm_b32 v36, v14, v14, v8
    v_perm_b32 v37, v14, v14, v9
    v_perm_b32 v38, v14, v14, v10
    v_perm_b32 v39, v14, v14, v11
    s_waitcnt vmcnt(23)
    v_mfma_f32_16x16x32_bf16 v[208:211], v[68:71], v[40:43], v[208:211]
    v_perm_b32 v40, v15, v15, v8
    v_perm_b32 v41, v15, v15, v9
    v_perm_b32 v42, v15, v15, v10
    v_perm_b32 v43, v15, v15, v11
    s_waitcnt vmcnt(22)
    v_mfma_f32_16x16x32_bf16 v[208:211], v[72:75], v[36:39], v[208:211]
    s_waitcnt lgkmcnt(4)
    v_perm_b32 v36, v16, v16, v8
    v_perm_b32 v37, v16, v16, v9
    v_perm_b32 v38, v16, v16, v10
    v_perm_b32 v39, v16, v16, v11
    s_waitcnt vmcnt(21)
    v_mfma_f32_16x16x32_bf16 v[208:211], v[76:79], v[40:43], v[208:211]
    v_perm_b32 v40, v17, v17, v8
    v_perm_b32 v41, v17, v17, v9
    v_perm_b32 v42, v17, v17, v10
    v_perm_b32 v43, v17, v17, v11
    s_waitcnt vmcnt(20)
    v_mfma_f32_16x16x32_bf16 v[208:211], v[80:83], v[36:39], v[208:211]
    v_perm_b32 v36, v18, v18, v8
    v_perm_b32 v37, v18, v18, v9
    v_perm_b32 v38, v18, v18, v10
    v_perm_b32 v39, v18, v18, v11
    s_waitcnt vmcnt(19)
    v_mfma_f32_16x16x32_bf16 v[208:211], v[84:87], v[40:43], v[208:211]
    v_perm_b32 v40, v19, v19, v8
    v_perm_b32 v41, v19, v19, v9
    v_perm_b32 v42, v19, v19, v10
    v_perm_b32 v43, v19, v19, v11
    s_waitcnt vmcnt(18)
    v_mfma_f32_16x16x32_bf16 v[208:211], v[88:91], v[36:39], v[208:211]
    s_waitcnt lgkmcnt(3)
    v_perm_b32 v36, v20, v20, v8
    v_perm_b32 v37, v20, v20, v9
    v_perm_b32 v38, v20, v20, v10
    v_perm_b32 v39, v20, v20, v11
    s_waitcnt vmcnt(17)
    v_mfma_f32_16x16x32_bf16 v[208:211], v[92:95], v[40:43], v[208:211]
    v_perm_b32 v40, v21, v21, v8
    v_perm_b32 v41, v21, v21, v9
    v_perm_b32 v42, v21, v21, v10
    v_perm_b32 v43, v21, v21, v11
    s_waitcnt vmcnt(16)
    v_mfma_f32_16x16x32_bf16 v[208:211], v[96:99], v[36:39], v[208:211]
    v_perm_b32 v36, v22, v22, v8
    v_perm_b32 v37, v22, v22, v9
    v_perm_b32 v38, v22, v22, v10
    v_perm_b32 v39, v22, v22, v11
    s_waitcnt vmcnt(15)
    v_mfma_f32_16x16x32_bf16 v[208:211], v[100:103], v[40:43], v[208:211]
    v_perm_b32 v40, v23, v23, v8
    v_perm_b32 v41, v23, v23, v9
    v_perm_b32 v42, v23, v23, v10
    v_perm_b32 v43, v23, v23, v11
    s_waitcnt vmcnt(14)
    v_mfma_f32_16x16x32_bf16 v[208:211], v[104:107], v[36:39], v[208:211]
    s_waitcnt lgkmcnt(2)
    v_perm_b32 v36, v24, v24, v8
    v_perm_b32 v37, v24, v24, v9
    v_perm_b32 v38, v24, v24, v10
    v_perm_b32 v39, v24, v24, v11
    s_waitcnt vmcnt(13)
    v_mfma_f32_16x16x32_bf16 v[208:211], v[108:111], v[40:43], v[208:211]
    v_perm_b32 v40, v25, v25, v8
    v_perm_b32 v41, v25, v25, v9
    v_perm_b32 v42, v25, v25, v10
    v_perm_b32 v43, v25, v25, v11
    s_waitcnt vmcnt(12)
    v_mfma_f32_16x16x32_bf16 v[208:211], v[112:115], v[36:39], v[208:211]
    v_perm_b32 v36, v26, v26, v8
    v_perm_b32 v37, v26, v26, v9
    v_perm_b32 v38, v26, v26, v10
    v_perm_b32 v39, v26, v26, v11
    s_waitcnt vmcnt(11)
    v_mfma_f32_16x16x32_bf16 v[208:211], v[116:119], v[40:43], v[208:211]
    v_perm_b32 v40, v27, v27, v8
    v_perm_b32 v41, v27, v27, v9
    v_perm_b32 v42, v27, v27, v10
    v_perm_b32 v43, v27, v27, v11
    s_waitcnt vmcnt(10)
    v_mfma_f32_16x16x32_bf16 v[208:211], v[120:123], v[36:39], v[208:211]
    s_waitcnt lgkmcnt(1)
    v_perm_b32 v36, v28, v28, v8
    v_perm_b32 v37, v28, v28, v9
    v_perm_b32 v38, v28, v28, v10
    v_perm_b32 v39, v28, v28, v11
    s_waitcnt vmcnt(9)
    v_mfma_f32_16x16x32_bf16 v[208:211], v[124:127], v[40:43], v[208:211]
    v_perm_b32 v40, v29, v29, v8
    v_perm_b32 v41, v29, v29, v9
    v_perm_b32 v42, v29, v29, v10
    v_perm_b32 v43, v29, v29, v11
    s_waitcnt vmcnt(8)
    v_mfma_f32_16x16x32_bf16 v[208:211], v[128:131], v[36:39], v[208:211]
    v_perm_b32 v36, v30, v30, v8
    v_perm_b32 v37, v30, v30, v9
    v_perm_b32 v38, v30, v30, v10
    v_perm_b32 v39, v30, v30, v11
    s_waitcnt vmcnt(7)
    v_mfma_f32_16x16x32_bf16 v[208:211], v[132:135], v[40:43], v[208:211]
    v_perm_b32 v40, v31, v31, v8
    v_perm_b32 v41, v31, v31, v9
    v_perm_b32 v42, v31, v31, v10
    v_perm_b32 v43, v31, v31, v11
    s_waitcnt vmcnt(6)
    v_mfma_f32_16x16x32_bf16 v[208:211], v[136:139], v[36:39], v[208:211]
    s_waitcnt lgkmcnt(0)
    v_perm_b32 v36, v32, v32, v8
    v_perm_b32 v37, v32, v32, v9
    v_perm_b32 v38, v32, v32, v10
    v_perm_b32 v39, v32, v32, v11
    s_waitcnt vmcnt(5)
    v_mfma_f32_16x16x32_bf16 v[208:211], v[140:143], v[40:43], v[208:211]
    v_perm_b32 v40, v33, v33, v8
    v_perm_b32 v41, v33, v33, v9
    v_perm_b32 v42, v33, v33, v10
    v_perm_b32 v43, v33, v33, v11
    s_waitcnt vmcnt(4)
    v_mfma_f32_16x16x32_bf16 v[208:211], v[144:147], v[36:39], v[208:211]
    v_perm_b32 v36, v34, v34, v8
    v_perm_b32 v37, v34, v34, v9
    v_perm_b32 v38, v34, v34, v10
    v_perm_b32 v39, v34, v34, v11
    s_waitcnt vmcnt(3)
    v_mfma_f32_16x16x32_bf16 v[208:211], v[148:151], v[40:43], v[208:211]
    v_perm_b32 v40, v35, v35, v8
    v_perm_b32 v41, v35, v35, v9
    v_perm_b32 v42, v35, v35, v10
    v_perm_b32 v43, v35, v35, v11
    s_waitcnt vmcnt(2)
    v_mfma_f32_16x16x32_bf16 v[208:211], v[152:155], v[36:39], v[208:211]
    s_waitcnt vmcnt(1)
    v_mfma_f32_16x16x32_bf16 v[208:211], v[156:159], v[40:43], v[208:211]
    v_mov_b32 v213, s60
    v_mov_b32 v215, s60
    s_nop 5
    v_permlane32_swap_b32 v208, v210
    v_permlane32_swap_b32 v209, v211
    s_nop 0
    v_add_f32_dpp v212, v210, v208 row_ror:8 row_mask:0xf bank_mask:0xf
    v_add_f32_dpp v214, v211, v209 row_ror:8 row_mask:0xf bank_mask:0xf
    s_waitcnt vmcnt(0)
    s_mov_b32 exec_lo, 0x00ff00ff
    s_mov_b32 exec_hi, 0x00ff00ff
    buffer_store_dwordx4 v[212:215], v5, s[32:35], s50 offen sc1
    s_mov_b64 exec, -1
    s_branch L_hb1
L_h1:
    s_cmp_ge_u32 s2, 64
    s_cbranch_scc1 L_h1j
    s_barrier
    s_waitcnt lgkmcnt(0)
    s_mul_i32 s60, s60, 1664525
    s_add_u32 s60, s60, 1013904223
    s_branch L_hb1
L_h1j:
    s_mov_b32 s36, s4
    s_mov_b32 s37, s5
    s_mov_b32 s38, 1152
    s_mov_b32 s39, 0x20000
    s_mov_b32 s40, s10
    s_mov_b32 s41, s11
    s_mov_b32 s42, 4718592
    s_mov_b32 s43, 0x20000
    s_and_b32 s48, s98, 7
    s_lshl_b32 s49, s97, 3
    s_or_b32 s48, s48, s49
    s_lshr_b32 s49, s2, 6
    s_sub_u32 s49, s49, 1
    s_mul_i32 s50, s49, 384
    s_add_u32 s51, s50, 384
    s_cmp_eq_u32 s51, 1152
    s_cselect_b32 s51, 0, s51
    s_add_u32 s52, s51, 384
    s_cmp_eq_u32 s52, 1152
    s_cselect_b32 s52, 0, s52
    v_mov_b32 v160, 0
    v_mov_b32 v161, 0
    v_mov_b32 v162, 0
    v_mov_b32 v163, 0
    v_mov_b32 v164, 0
    v_mov_b32 v165, 0
    v_mov_b32 v166, 0
    v_mov_b32 v167, 0
    v_mov_b32 v168, 0
    buffer_load_short_d16_hi v160, v2, s[36:39], s50 offen offset:0
    buffer_load_short_d16_hi v161, v2, s[36:39], s50 offen offset:128
    buffer_load_short_d16_hi v162, v2, s[36:39], s50 offen offset:256
    buffer_load_short_d16_hi v163, v2, s[36:39], s51 offen offset:0
    buffer_load_short_d16_hi v164, v2, s[36:39], s51 offen offset:128
    buffer_load_short_d16_hi v165, v2, s[36:39], s51 offen offset:256
    buffer_load_short_d16_hi v166, v2, s[36:39], s52 offen offset:0
    buffer_load_short_d16_hi v167, v2, s[36:39], s52 offen offset:128
    buffer_load_short_d16_hi v168, v2, s[36:39], s52 offen offset:256
    s_mul_i32 s51, s49, 1572864
    s_lshl_b32 s50, s48, 7
    s_add_u32 s51, s51, s50
    v_mul_u32_u24 v4, 48, v1
    v_bfe_u32 v44, v0, 3, 1
    v_add_u32 v4, v4, v44
    v_mul_u32_u24 v4, 8192, v4
    v_and_b32 v44, 7, v0
    v_lshl_add_u32 v4, v44, 4, v4
    buffer_load_dwordx4 v[64:67], v4, s[40:43], s51 offen nt
    s_add_u32 s51, s51, 16384
    buffer_load_dwordx4 v[68:71], v4, s[40:43], s51 offen nt
    s_add_u32 s51, s51, 16384
    buffer_load_dwordx4 v[72:75], v4, s[40:43], s51 offen nt
    s_add_u32 s51, s51, 16384
    buffer_load_dwordx4 v[76:79], v4, s[40:43], s51 offen nt
    s_add_u32 s51, s51, 16384
    buffer_load_dwordx4 v[80:83], v4, s[40:43], s51 offen nt
    s_add_u32 s51, s51, 16384
    buffer_load_dwordx4 v[84:87], v4, s[40:43], s51 offen nt
    s_add_u32 s51, s51, 16384
    buffer_load_dwordx4 v[88:91], v4, s[40:43], s51 offen nt
    s_add_u32 s51, s51, 16384
    buffer_load_dwordx4 v[92:95], v4, s[40:43], s51 offen nt
    s_add_u32 s51, s51, 16384
    buffer_load_dwordx4 v[96:99], v4, s[40:43], s51 offen nt
    s_add_u32 s51, s51, 16384
    buffer_load_dwordx4 v[100:103], v4, s[40:43], s51 offen nt
    s_add_u32 s51, s51, 16384
    buffer_load_dwordx4 v[104:107], v4, s[40:43], s51 offen nt
    s_add_u32 s51, s51, 16384
    buffer_load_dwordx4 v[108:111], v4, s[40:43], s51 offen nt
    s_add_u32 s51, s51, 16384
    buffer_load_dwordx4 v[112:115], v4, s[40:43], s51 offen nt
    s_add_u32 s51, s51, 16384
    buffer_load_dwordx4 v[116:119], v4, s[40:43], s51 offen nt
    s_add_u32 s51, s51, 16384
    buffer_load_dwordx4 v[120:123], v4, s[40:43], s51 offen nt
    s_add_u32 s51, s51, 16384
    buffer_load_dwordx4 v[124:127], v4, s[40:43], s51 offen nt
    s_add_u32 s51, s51, 16384
    buffer_load_dwordx4 v[128:131], v4, s[40:43], s51 offen nt
    s_add_u32 s51, s51, 16384
    buffer_load_dwordx4 v[132:135], v4, s[40:43], s51 offen nt
    s_add_u32 s51, s51, 16384
    buffer_load_dwordx4 v[136:139], v4, s[40:43], s51 offen nt
    s_add_u32 s51, s51, 16384
    buffer_load_dwordx4 v[140:143], v4, s[40:43], s51 offen nt
    s_add_u32 s51, s51, 16384
    buffer_load_dwordx4 v[144:147], v4, s[40:43], s51 offen nt
    s_add_u32 s51, s51, 16384
    buffer_load_dwordx4 v[148:151], v4, s[40:43], s51 offen nt
    s_add_u32 s51, s51, 16384
    buffer_load_dwordx4 v[152:155], v4, s[40:43], s51 offen nt
    s_add_u32 s51, s51, 16384
    buffer_load_dwordx4 v[156:159], v4, s[40:43], s51 offen nt
    s_barrier
    v_bfe_u32 v44, v0, 3, 1
    v_mul_u32_u24 v44, 0x0202, v44
    v_add_u32 v44, 0x0100, v44
    v_or_b32 v45, 0x0c0c0000, v44
    v_lshlrev_b32 v44, 16, v44
    v_or_b32 v44, 0x0c0c, v44
    v_and_b32 v46, 1, v0
    v_cmp_eq_u32 vcc, 1, v46
    s_nop 1
    v_cndmask_b32 v44, v45, v44, vcc
    v_bfe_u32 v46, v0, 1, 2
    v_mov_b32 v45, 0x0c0c0c0c
    v_cmp_eq_u32 vcc, 0, v46
    s_nop 1
    v_cndmask_b32 v8, v45, v44, vcc
    v_cmp_eq_u32 vcc, 1, v46
    s_nop 1
    v_cndmask_b32 v9, v45, v44, vcc
    v_cmp_eq_u32 vcc, 2, v46
    s_nop 1
    v_cndmask_b32 v10, v45, v44, vcc
    v_cmp_eq_u32 vcc, 3, v46
    s_nop 1
    v_cndmask_b32 v11, v45, v44, vcc
    v_and_b32 v5, 1, v1
    v_lshlrev_b32 v5, 8, v5
    v_and_b32 v44, 7, v0
    v_lshl_add_u32 v5, v44, 4, v5
    v_lshrrev_b32 v44, 5, v0
    v_lshl_add_u32 v5, v44, 7, v5
    v_mul_u32_u24 v3, 96, v1
    v_and_b32 v7, 48, v0
    v_and_b32 v44, 7, v0
    v_lshl_add_u32 v7, v44, 1, v7
    v_bfe_u32 v44, v0, 3, 1
    v_add_lshl_u32 v7, v7, v44, 3
    s_lshl_b32 s56, s49, 6
    s_add_u32 s56, s56, s48
    s_lshl_b32 s56, s56, 9
    s_add_u32 s56, s56, 106496
    s_mul_i32 s57, s49, 1536
    s_add_u32 s50, s57, 16384
    s_add_u32 s51, s57, 20992
    s_add_u32 s52, s57, 44032
    s_add_u32 s53, s57, 48640
    s_add_u32 s54, s57, 71680
    s_add_u32 s55, s57, 76288
    s_waitcnt lgkmcnt(0)
    s_mul_i32 s60, s60, 1664525
    s_add_u32 s60, s60, 1013904223
    s_waitcnt vmcnt(24)
    v_readfirstlane_b32 s30, v160
    s_nop 1
    v_subrev_f32 v48, s30, v160
    v_subrev_f32 v49, s30, v161
    v_subrev_f32 v50, s30, v162
    v_subrev_f32 v51, s30, v163
    v_subrev_f32 v52, s30, v164
    v_subrev_f32 v53, s30, v165
    v_subrev_f32 v54, s30, v166
    v_subrev_f32 v55, s30, v167
    v_subrev_f32 v56, s30, v168
    v_add_f32 v44, v48, v49
    v_mul_f32 v47, v48, v48
    v_fmac_f32 v47, v49, v49
    v_add_f32 v44, v44, v50
    v_fmac_f32 v47, v50, v50
    v_add_f32 v44, v44, v51
    v_fmac_f32 v47, v51, v51
    v_add_f32 v44, v44, v52
    v_fmac_f32 v47, v52, v52
    v_add_f32 v44, v44, v53
    v_fmac_f32 v47, v53, v53
    v_add_f32 v44, v44, v54
    v_fmac_f32 v47, v54, v54
    v_add_f32 v44, v44, v55
    v_fmac_f32 v47, v55, v55
    v_add_f32 v44, v44, v56
    v_fmac_f32 v47, v56, v56
    s_nop 0
    v_add_f32_dpp v44, v44, v44 quad_perm:[1,0,3,2] row_mask:0xf bank_mask:0xf
    v_add_f32_dpp v47, v47, v47 quad_perm:[1,0,3,2] row_mask:0xf bank_mask:0xf
    s_nop 0
    v_add_f32_dpp v44, v44, v44 quad_perm:[2,3,0,1] row_mask:0xf bank_mask:0xf
    v_add_f32_dpp v47, v47, v47 quad_perm:[2,3,0,1] row_mask:0xf bank_mask:0xf
    s_nop 0
    v_add_f32_dpp v44, v44, v44 row_half_mirror row_mask:0xf bank_mask:0xf
    v_add_f32_dpp v47, v47, v47 row_half_mirror row_mask:0xf bank_mask:0xf
    s_nop 0
    v_add_f32_dpp v44, v44, v44 row_mirror row_mask:0xf bank_mask:0xf
    v_add_f32_dpp v47, v47, v47 row_mirror row_mask:0xf bank_mask:0xf
    s_nop 1
    v_permlane16_swap_b32 v44, v47
    v_add_f32 v44, v44, v47
    s_nop 0
    v_readlane_b32 s44, v44, 0
    v_readlane_b32 s45, v44, 16
    v_readlane_b32 s46, v44, 32
    v_readlane_b32 s47, v44, 48
    v_mov_b32 v46, s44
    v_mov_b32 v47, s45
    v_add_f32 v46, s46, v46
    v_add_f32 v47, s47, v47
    v_mul_f32 v46, 987991609, v46
    v_mul_f32 v47, 987991609, v47
    v_fma_f32 v44, -v46, v46, v47
    v_add_f32 v46, s30, v46
    v_max_f32 v44, 0, v44
    v_cvt_pk_bf16_f32 v46, 0, v46
    v_cvt_pk_bf16_f32 v44, 0, v44
    v_add_f32 v44, 925353388, v44
    v_cvt_pk_bf16_f32 v44, 0, v44
    v_sqrt_f32 v44, v44
    v_sub_f32 v160, v160, v46
    v_sub_f32 v161, v161, v46
    v_sub_f32 v162, v162, v46
    v_cvt_pk_bf16_f32 v44, 0, v44
    v_rcp_f32 v44, v44
    v_cvt_pk_bf16_f32 v160, 0, v160
    v_cvt_pk_bf16_f32 v161, 0, v161
    v_cvt_pk_bf16_f32 v162, 0, v162
    v_mul_f32 v160, v160, v44
    v_mul_f32 v161, v161, v44
    v_mul_f32 v162, v162, v44
    v_cvt_pk_bf16_f32 v160, 0, v160
    v_cvt_pk_bf16_f32 v161, 0, v161
    v_cvt_pk_bf16_f32 v162, 0, v162
    s_mov_b32 s61, 0
L_gm_172:
    buffer_load_dwordx2 v[170:171], v7, s[32:35], s55 offen offset:1024 sc1
    s_waitcnt vmcnt(0)
    v_cmp_ne_u32 vcc, s60, v171
    s_add_u32 s61, s61, 1
    s_cmp_gt_u32 s61, 200000
    s_cbranch_scc1 L_pd_173
    s_cbranch_vccz L_pd_173
    s_sleep 2
    s_branch L_gm_172
L_pd_173:
    v_and_b32 v46, 31, v0
    v_lshlrev_b32 v46, 3, v46
    s_lshl_b32 s30, s97, 8
    s_add_u32 s30, s30, 4096
    buffer_load_dwordx2 v[48:49], v46, s[32:35], s30 offen sc1
    s_mov_b32 s61, 0
L_gm_174:
    buffer_load_dwordx2 v[170:171], v7, s[32:35], s50 offen offset:0 sc1
    buffer_load_dwordx2 v[172:173], v7, s[32:35], s50 offen offset:512 sc1
    buffer_load_dwordx2 v[174:175], v7, s[32:35], s50 offen offset:1024 sc1
    buffer_load_dwordx2 v[176:177], v7, s[32:35], s51 offen offset:0 sc1
    buffer_load_dwordx2 v[178:179], v7, s[32:35], s51 offen offset:512 sc1
    buffer_load_dwordx2 v[180:181], v7, s[32:35], s51 offen offset:1024 sc1
    buffer_load_dwordx2 v[182:183], v7, s[32:35], s52 offen offset:0 sc1
    buffer_load_dwordx2 v[184:185], v7, s[32:35], s52 offen offset:512 sc1
    buffer_load_dwordx2 v[186:187], v7, s[32:35], s52 offen offset:1024 sc1
    buffer_load_dwordx2 v[188:189], v7, s[32:35], s53 offen offset:0 sc1
    buffer_load_dwordx2 v[190:191], v7, s[32:35], s53 offen offset:512 sc1
    buffer_load_dwordx2 v[192:193], v7, s[32:35], s53 offen offset:1024 sc1
    buffer_load_dwordx2 v[194:195], v7, s[32:35], s54 offen offset:0 sc1
    buffer_load_dwordx2 v[196:197], v7, s[32:35], s54 offen offset:512 sc1
    buffer_load_dwordx2 v[198:199], v7, s[32:35], s54 offen offset:1024 sc1
    buffer_load_dwordx2 v[200:201], v7, s[32:35], s55 offen offset:0 sc1
    buffer_load_dwordx2 v[202:203], v7, s[32:35], s55 offen offset:512 sc1
    buffer_load_dwordx2 v[204:205], v7, s[32:35], s55 offen offset:1024 sc1
    s_waitcnt vmcnt(0)
    v_min_u32 v44, v171, v173
    v_min3_u32 v44, v44, v175, v177
    v_min3_u32 v44, v44, v179, v181
    v_min3_u32 v44, v44, v183, v185
    v_min3_u32 v44, v44, v187, v189
    v_min3_u32 v44, v44, v191, v193
    v_min3_u32 v44, v44, v195, v197
    v_min3_u32 v44, v44, v199, v201
    v_min3_u32 v44, v44, v203, v205
    v_max_u32 v45, v171, v173
    v_max3_u32 v45, v45, v175, v177
    v_max3_u32 v45, v45, v179, v181
    v_max3_u32 v45, v45, v183, v185
    v_max3_u32 v45, v45, v187, v189
    v_max3_u32 v45, v45, v191, v193
    v_max3_u32 v45, v45, v195, v197
    v_max3_u32 v45, v45, v199, v201
    v_max3_u32 v45, v45, v203, v205
    v_cmp_ne_u32 s[30:31], s60, v44
    v_cmp_ne_u32 vcc, s60, v45
    s_or_b64 vcc, vcc, s[30:31]
    s_add_u32 s61, s61, 1
    s_cmp_gt_u32 s61, 200000
    s_cbranch_scc1 L_pd_175
    s_cbranch_vccnz L_gm_174
L_pd_175:
    s_getreg_b32 s31, hwreg(HW_REG_XCC_ID, 0, 4)
    s_waitcnt vmcnt(0)
    v_cmp_ne_u32 vcc, s31, v48
    v_cmp_ne_u32 s[30:31], s60, v49
    s_or_b64 vcc, vcc, s[30:31]
    s_cmp_eq_u64 vcc, 0
    s_cselect_b32 s63, 1, 0
    v_add_f32 v170, v170, v182
    v_add_f32 v172, v172, v184
    v_add_f32 v174, v174, v186
    v_add_f32 v176, v176, v188
    v_add_f32 v178, v178, v190
    v_add_f32 v180, v180, v192
    v_add_f32 v170, v170, v194
    v_add_f32 v172, v172, v196
    v_add_f32 v174, v174, v198
    v_add_f32 v176, v176, v200
    v_add_f32 v178, v178, v202
    v_add_f32 v180, v180, v204
    v_cvt_pk_bf16_f32 v170, 0, v170
    v_cvt_pk_bf16_f32 v172, 0, v172
    v_cvt_pk_bf16_f32 v174, 0, v174
    v_cvt_pk_bf16_f32 v176, 0, v176
    v_cvt_pk_bf16_f32 v178, 0, v178
    v_cvt_pk_bf16_f32 v180, 0, v180
    v_add_f32 v176, 1.0, v176
    v_add_f32 v178, 1.0, v178
    v_add_f32 v180, 1.0, v180
    v_cvt_pk_bf16_f32 v176, 0, v176
    v_cvt_pk_bf16_f32 v178, 0, v178
    v_cvt_pk_bf16_f32 v180, 0, v180
    v_mul_f32 v160, v160, v176
    v_mul_f32 v161, v161, v178
    v_mul_f32 v162, v162, v180
    v_cvt_pk_bf16_f32 v160, 0, v160
    v_cvt_pk_bf16_f32 v161, 0, v161
    v_cvt_pk_bf16_f32 v162, 0, v162
    v_add_f32 v160, v160, v170
    v_add_f32 v161, v161, v172
    v_add_f32 v162, v162, v174
    v_cvt_pk_bf16_f32 v160, 0, v160
    v_cvt_pk_bf16_f32 v161, 0, v161
    v_cvt_pk_bf16_f32 v162, 0, v162
    ds_write_b16_d16_hi v2, v160 offset:512
    ds_write_b16_d16_hi v2, v161 offset:640
    ds_write_b16_d16_hi v2, v162 offset:768
    ds_read_b128 v[12:15], v3 offset:512
    ds_read_b128 v[16:19], v3 offset:528
    ds_read_b128 v[20:23], v3 offset:544
    ds_read_b128 v[24:27], v3 offset:560
    ds_read_b128 v[28:31], v3 offset:576
    ds_read_b128 v[32:35], v3 offset:592
    s_waitcnt lgkmcnt(5)
    v_perm_b32 v36, v12, v12, v8
    v_perm_b32 v37, v12, v12, v9
    v_perm_b32 v38, v12, v12, v10
    v_perm_b32 v39, v12, v12, v11
    v_perm_b32 v40, v13, v13, v8
    v_perm_b32 v41, v13, v13, v9
    v_perm_b32 v42, v13, v13, v10
    v_perm_b32 v43, v13, v13, v11
    v_mfma_f32_16x16x32_bf16 v[208:211], v[64:67], v[36:39], 0
    v_perm_b32 v36, v14, v14, v8
    v_perm_b32 v37, v14, v14, v9
    v_perm_b32 v38, v14, v14, v10
    v_perm_b32 v39, v14, v14, v11
    v_mfma_f32_16x16x32_bf16 v[208:211], v[68:71], v[40:43], v[208:211]
    v_perm_b32 v40, v15, v15, v8
    v_perm_b32 v41, v15, v15, v9
    v_perm_b32 v42, v15, v15, v10
    v_perm_b32 v43, v15, v15, v11
    v_mfma_f32_16x16x32_bf16 v[208:211], v[72:75], v[36:39], v[208:211]
    s_waitcnt lgkmcnt(4)
    v_perm_b32 v36, v16, v16, v8
    v_perm_b32 v37, v16, v16, v9
    v_perm_b32 v38, v16, v16, v10
    v_perm_b32 v39, v16, v16, v11
    v_mfma_f32_16x16x32_bf16 v[208:211], v[76:79], v[40:43], v[208:211]
    v_perm_b32 v40, v17, v17, v8
    v_perm_b32 v41, v17, v17, v9
    v_perm_b32 v42, v17, v17, v10
    v_perm_b32 v43, v17, v17, v11
    v_mfma_f32_16x16x32_bf16 v[208:211], v[80:83], v[36:39], v[208:211]
    v_perm_b32 v36, v18, v18, v8
    v_perm_b32 v37, v18, v18, v9
    v_perm_b32 v38, v18, v18, v10
    v_perm_b32 v39, v18, v18, v11
    v_mfma_f32_16x16x32_bf16 v[208:211], v[84:87], v[40:43], v[208:211]
    v_perm_b32 v40, v19, v19, v8
    v_perm_b32 v41, v19, v19, v9
    v_perm_b32 v42, v19, v19, v10
    v_perm_b32 v43, v19, v19, v11
    v_mfma_f32_16x16x32_bf16 v[208:211], v[88:91], v[36:39], v[208:211]
    s_waitcnt lgkmcnt(3)
    v_perm_b32 v36, v20, v20, v8
    v_perm_b32 v37, v20, v20, v9
    v_perm_b32 v38, v20, v20, v10
    v_perm_b32 v39, v20, v20, v11
    v_mfma_f32_16x16x32_bf16 v[208:211], v[92:95], v[40:43], v[208:211]
    v_perm_b32 v40, v21, v21, v8
    v_perm_b32 v41, v21, v21, v9
    v_perm_b32 v42, v21, v21, v10
    v_perm_b32 v43, v21, v21, v11
    v_mfma_f32_16x16x32_bf16 v[208:211], v[96:99], v[36:39], v[208:211]
    v_perm_b32 v36, v22, v22, v8
    v_perm_b32 v37, v22, v22, v9
    v_perm_b32 v38, v22, v22, v10
    v_perm_b32 v39, v22, v22, v11
    v_mfma_f32_16x16x32_bf16 v[208:211], v[100:103], v[40:43], v[208:211]
    v_perm_b32 v40, v23, v23, v8
    v_perm_b32 v41, v23, v23, v9
    v_perm_b32 v42, v23, v23, v10
    v_perm_b32 v43, v23, v23, v11
    v_mfma_f32_16x16x32_bf16 v[208:211], v[104:107], v[36:39], v[208:211]
    s_waitcnt lgkmcnt(2)
    v_perm_b32 v36, v24, v24, v8
    v_perm_b32 v37, v24, v24, v9
    v_perm_b32 v38, v24, v24, v10
    v_perm_b32 v39, v24, v24, v11
    v_mfma_f32_16x16x32_bf16 v[208:211], v[108:111], v[40:43], v[208:211]
    v_perm_b32 v40, v25, v25, v8
    v_perm_b32 v41, v25, v25, v9
    v_perm_b32 v42, v25, v25, v10
    v_perm_b32 v43, v25, v25, v11
    v_mfma_f32_16x16x32_bf16 v[208:211], v[112:115], v[36:39], v[208:211]
    v_perm_b32 v36, v26, v26, v8
    v_perm_b32 v37, v26, v26, v9
    v_perm_b32 v38, v26, v26, v10
    v_perm_b32 v39, v26, v26, v11
    v_mfma_f32_16x16x32_bf16 v[208:211], v[116:119], v[40:43], v[208:211]
    v_perm_b32 v40, v27, v27, v8
    v_perm_b32 v41, v27, v27, v9
    v_perm_b32 v42, v27, v27, v10
    v_perm_b32 v43, v27, v27, v11
    v_mfma_f32_16x16x32_bf16 v[208:211], v[120:123], v[36:39], v[208:211]
    s_waitcnt lgkmcnt(1)
    v_perm_b32 v36, v28, v28, v8
    v_perm_b32 v37, v28, v28, v9
    v_perm_b32 v38, v28, v28, v10
    v_perm_b32 v39, v28, v28, v11
    v_mfma_f32_16x16x32_bf16 v[208:211], v[124:127], v[40:43], v[208:211]
    v_perm_b32 v40, v29, v29, v8
    v_perm_b32 v41, v29, v29, v9
    v_perm_b32 v42, v29, v29, v10
    v_perm_b32 v43, v29, v29, v11
    v_mfma_f32_16x16x32_bf16 v[208:211], v[128:131], v[36:39], v[208:211]
    v_perm_b32 v36, v30, v30, v8
    v_perm_b32 v37, v30, v30, v9
    v_perm_b32 v38, v30, v30, v10
    v_perm_b32 v39, v30, v30, v11
    v_mfma_f32_16x16x32_bf16 v[208:211], v[132:135], v[40:43], v[208:211]
    v_perm_b32 v40, v31, v31, v8
    v_perm_b32 v41, v31, v31, v9
    v_perm_b32 v42, v31, v31, v10
    v_perm_b32 v43, v31, v31, v11
    v_mfma_f32_16x16x32_bf16 v[208:211], v[136:139], v[36:39], v[208:211]
    s_waitcnt lgkmcnt(0)
    v_perm_b32 v36, v32, v32, v8
    v_perm_b32 v37, v32, v32, v9
    v_perm_b32 v38, v32, v32, v10
    v_perm_b32 v39, v32, v32, v11
    v_mfma_f32_16x16x32_bf16 v[208:211], v[140:143], v[40:43], v[208:211]
    v_perm_b32 v40, v33, v33, v8
    v_perm_b32 v41, v33, v33, v9
    v_perm_b32 v42, v33, v33, v10
    v_perm_b32 v43, v33, v33, v11
    v_mfma_f32_16x16x32_bf16 v[208:211], v[144:147], v[36:39], v[208:211]
    v_perm_b32 v36, v34, v34, v8
    v_perm_b32 v37, v34, v34, v9
    v_perm_b32 v38, v34, v34, v10
    v_perm_b32 v39, v34, v34, v11
    v_mfma_f32_16x16x32_bf16 v[208:211], v[148:151], v[40:43], v[208:211]
    v_perm_b32 v40, v35, v35, v8
    v_perm_b32 v41, v35, v35, v9
    v_perm_b32 v42, v35, v35, v10
    v_perm_b32 v43, v35, v35, v11
    v_mfma_f32_16x16x32_bf16 v[208:211], v[152:155], v[36:39], v[208:211]
    s_nop 0
    v_mfma_f32_16x16x32_bf16 v[208:211], v[156:159], v[40:43], v[208:211]
    v_mov_b32 v213, s60
    v_mov_b32 v215, s60
    s_nop 5
    v_permlane32_swap_b32 v208, v210
    v_permlane32_swap_b32 v209, v211
    s_nop 0
    v_add_f32_dpp v212, v210, v208 row_ror:8 row_mask:0xf bank_mask:0xf
    v_add_f32_dpp v214, v211, v209 row_ror:8 row_mask:0xf bank_mask:0xf
    s_mov_b32 exec_lo, 0x00ff00ff
    s_mov_b32 exec_hi, 0x00ff00ff
    s_cmp_eq_u32 s63, 1
    s_cbranch_scc1 L_ls_176
    buffer_store_dwordx4 v[212:215], v5, s[32:35], s56 offen sc1
    s_branch L_le_177
L_ls_176:
    buffer_store_dwordx4 v[212:215], v5, s[32:35], s56 offen
L_le_177:
    s_mov_b64 exec, -1
    s_branch L_hb1
L_h012:
    s_barrier
    s_waitcnt lgkmcnt(0)
    s_mul_i32 s60, s60, 1664525
    s_add_u32 s60, s60, 1013904223
    s_cmp_lg_u32 s3, 1
    s_cbranch_scc1 L_noxid
    s_getreg_b32 s31, hwreg(HW_REG_XCC_ID, 0, 4)
    v_mov_b32 v44, s31
    v_mov_b32 v45, s60
    s_lshl_b32 s30, s99, 3
    s_add_u32 s30, s30, 4096
    s_mov_b64 exec, 1
    buffer_store_dwordx2 v[44:45], v2, s[32:35], s30 offen
    s_mov_b64 exec, -1
L_noxid:
    s_sub_u32 s49, s98, 14
    s_cmp_ge_u32 s49, 9
    s_cbranch_scc1 L_nowo
    s_mov_b32 s36, s12
    s_mov_b32 s37, s13
    s_mov_b32 s38, 4718592
    s_mov_b32 s39, 0x20000
    v_bfe_u32 v44, v0, 3, 1
    v_lshl_add_u32 v4, v1, 2, v44
    v_mul_u32_u24 v4, 9216, v4
    v_and_b32 v44, 7, v0
    v_lshl_add_u32 v4, v44, 4, v4
    s_lshl_b32 s48, s97, 2
    s_add_u32 s48, s48, s3
    s_mul_i32 s48, s48, 147456
    s_lshl_b32 s49, s98, 7
    s_add_u32 s48, s48, s49
    s_sub_u32 s48, s48, 1792
    s_add_u32 s49, s48, 0
    buffer_load_dwordx4 v[64:67], v4, s[36:39], s49 offen nt
    s_add_u32 s49, s48, 18432
    buffer_load_dwordx4 v[68:71], v4, s[36:39], s49 offen nt
    s_add_u32 s49, s48, 1152
    buffer_load_dwordx4 v[72:75], v4, s[36:39], s49 offen nt
    s_add_u32 s49, s48, 19584
    buffer_load_dwordx4 v[76:79], v4, s[36:39], s49 offen nt
    s_add_u32 s49, s48, 2304
    buffer_load_dwordx4 v[80:83], v4, s[36:39], s49 offen nt
    s_add_u32 s49, s48, 20736
    buffer_load_dwordx4 v[84:87], v4, s[36:39], s49 offen nt
    s_add_u32 s49, s48, 3456
    buffer_load_dwordx4 v[88:91], v4, s[36:39], s49 offen nt
    s_add_u32 s49, s48, 21888
    buffer_load_dwordx4 v[92:95], v4, s[36:39], s49 offen nt
    s_add_u32 s49, s48, 4608
    buffer_load_dwordx4 v[96:99], v4, s[36:39], s49 offen nt
    s_add_u32 s49, s48, 23040
    buffer_load_dwordx4 v[100:103], v4, s[36:39], s49 offen nt
    s_add_u32 s49, s48, 5760
    buffer_load_dwordx4 v[104:107], v4, s[36:39], s49 offen nt
    s_add_u32 s49, s48, 24192
    buffer_load_dwordx4 v[108:111], v4, s[36:39], s49 offen nt
    s_add_u32 s49, s48, 6912
    buffer_load_dwordx4 v[112:115], v4, s[36:39], s49 offen nt
    s_add_u32 s49, s48, 25344
    buffer_load_dwordx4 v[116:119], v4, s[36:39], s49 offen nt
    s_add_u32 s49, s48, 8064
    buffer_load_dwordx4 v[120:123], v4, s[36:39], s49 offen nt
    s_add_u32 s49, s48, 26496
    buffer_load_dwordx4 v[124:127], v4, s[36:39], s49 offen nt
    s_branch L_h012b
L_nowo:
    s_cmp_lg_u32 s3, 0
    s_cbranch_scc1 L_h012b
    s_sub_u32 s50, 111, s2
    s_cmp_ge_u32 s50, 108
    s_cbranch_scc1 L_h012b
    s_mul_i32 s49, s50, 1821
    s_lshr_b32 s49, s49, 16
    s_mul_i32 s48, s49, 36
    s_sub_u32 s48, s50, s48
    s_add_u32 s48, s48, 18
    s_mov_b32 s52, 2097152
    s_mov_b32 s53, 0
    s_branch L_h0j
L_h012b:
    s_cmp_lg_u32 s3, 2
    s_cbranch_scc1 L_hb1
    v_lshlrev_b32 v4, 4, v0
    v_lshrrev_b32 v3, 5, v0
    v_lshlrev_b32 v3, 6, v3
    v_and_b32 v44, 24, v0
    v_lshl_add_u32 v3, v44, 1, v3
    v_and_b32 v44, 7, v0
    v_add_lshl_u32 v3, v3, v44, 1
    s_lshr_b32 s48, s99, 4
    s_lshl_b32 s48, s48, 11
    s_add_u32 s48, s48, 106496
    s_add_u32 s49, s48, 32768
    s_add_u32 s50, s49, 32768
    v_lshlrev_b32 v7, 3, v0
    v_and_b32 v7, 127, v7
    s_mov_b32 s61, 0
L_gm_178:
    buffer_load_dwordx2 v[160:161], v7, s[32:35], s50 offen offset:1920 sc1
    s_waitcnt vmcnt(0)
    v_cmp_ne_u32 vcc, s60, v161
    s_add_u32 s61, s61, 1
    s_cmp_gt_u32 s61, 200000
    s_cbranch_scc1 L_pd_179
    s_cbranch_vccz L_pd_179
    s_sleep 4
    s_branch L_gm_178
L_pd_179:
    s_mov_b32 s61, 0
L_qp:
    buffer_load_dwordx4 v[160:163], v4, s[32:35], s48 offen offset:0 sc1
    buffer_load_dwordx4 v[164:167], v4, s[32:35], s48 offen offset:1024 sc1
    buffer_load_dwordx4 v[168:171], v4, s[32:35], s49 offen offset:0 sc1
    buffer_load_dwordx4 v[172:175], v4, s[32:35], s49 offen offset:1024 sc1
    buffer_load_dwordx4 v[176:179], v4, s[32:35], s50 offen offset:0 sc1
    buffer_load_dwordx4 v[180:183], v4, s[32:35], s50 offen offset:1024 sc1
    s_waitcnt vmcnt(0)
    v_min_u32 v44, v161, v163
    v_min3_u32 v44, v44, v165, v167
    v_min3_u32 v44, v44, v169, v171
    v_min3_u32 v44, v44, v173, v175
    v_min3_u32 v44, v44, v177, v179
    v_min3_u32 v44, v44, v181, v183
    v_max_u32 v45, v161, v163
    v_max3_u32 v45, v45, v165, v167
    v_max3_u32 v45, v45, v169, v171
    v_max3_u32 v45, v45, v173, v175
    v_max3_u32 v45, v45, v177, v179
    v_max3_u32 v45, v45, v181, v183
    v_cmp_ne_u32 s[30:31], s60, v44
    v_cmp_ne_u32 vcc, s60, v45
    s_or_b64 vcc, vcc, s[30:31]
    s_add_u32 s61, s61, 1
    s_cmp_gt_u32 s61, 200000
    s_cbranch_scc1 L_pd_180
    s_cbranch_vccnz L_qp
L_pd_180:
    v_add_f32 v160, v160, v168
    v_add_f32 v162, v162, v170
    v_add_f32 v164, v164, v172
    v_add_f32 v166, v166, v174
    v_add_f32 v160, v160, v176
    v_add_f32 v162, v162, v178
    v_add_f32 v164, v164, v180
    v_add_f32 v166, v166, v182
    v_cvt_pk_bf16_f32 v160, 0, v160
    v_cvt_pk_bf16_f32 v162, 0, v162
    v_cvt_pk_bf16_f32 v164, 0, v164
    v_cvt_pk_bf16_f32 v166, 0, v166
    ds_write_b16_d16_hi v3, v160 offset:1664
    ds_write_b16_d16_hi v3, v162 offset:1680
    ds_write_b16_d16_hi v3, v164 offset:1920
    ds_write_b16_d16_hi v3, v166 offset:1936
    s_waitcnt lgkmcnt(0)
L_hb1:
    s_barrier
L_roles:
    v_mov_b32 v23, 0xff
    s_and_b32 s88, s60, 0xff
    s_and_b32 s89, s60, 0xffff
    s_cmp_ge_u32 s98, 23
    s_cbranch_scc1 L_ffn
    s_cmp_ge_u32 s98, 14
    s_cbranch_scc1 L_red
    s_mov_b32 s91, 0
    s_cmp_eq_u32 s3, 1
    s_cbranch_scc1 L_sync0
    s_branch L_wend
L_red:
    s_sub_u32 s80, s98, 14
    s_lshl_b32 s80, s80, 1
    s_and_b32 s48, s3, 1
    s_add_u32 s80, s80, s48
    s_mov_b32 s44, s4
    s_mov_b32 s45, s5
    s_mov_b32 s46, 1152
    s_mov_b32 s47, 0x20000
    s_mov_b32 s40, s24
    s_mov_b32 s41, s25
    s_mov_b32 s42, 1152
    s_mov_b32 s43, 0x20000
    v_and_b32 v34, 7, v0
    v_lshl_add_u32 v13, v1, 3, v34
    s_lshl_b32 s81, s80, 6
    v_lshlrev_b32 v12, 1, v13
    v_lshlrev_b32 v13, 2, v13
    v_mov_b32 v14, 0
    buffer_load_short_d16_hi v14, v12, s[44:47], s81 offen
    v_lshrrev_b32 v4, 1, v1
    v_lshlrev_b32 v4, 4, v4
    v_lshl_add_u32 v4, v34, 1, v4
    v_and_b32 v32, 1, v1
    v_add_lshl_u32 v4, v4, v32, 3
    s_lshl_b32 s57, s80, 8
    s_add_u32 s48, s57, 25600
    s_add_u32 s49, s57, 39424
    s_add_u32 s50, s57, 53248
    s_add_u32 s51, s57, 67072
    s_add_u32 s52, s57, 80896
    s_add_u32 s53, s57, 94720
    s_mov_b32 s61, 0
L_gm_181:
    buffer_load_dwordx2 v[50:51], v4, s[32:35], s48 offen offset:0 sc1
    buffer_load_dwordx2 v[52:53], v4, s[32:35], s49 offen offset:0 sc1
    buffer_load_dwordx2 v[54:55], v4, s[32:35], s50 offen offset:0 sc1
    buffer_load_dwordx2 v[56:57], v4, s[32:35], s51 offen offset:0 sc1
    buffer_load_dwordx2 v[58:59], v4, s[32:35], s52 offen offset:0 sc1
    buffer_load_dwordx2 v[60:61], v4, s[32:35], s53 offen offset:0 sc1
    s_waitcnt vmcnt(0)
    v_min_u32 v32, v51, v53
    v_min3_u32 v32, v32, v55, v57
    v_min3_u32 v32, v32, v59, v61
    v_max_u32 v33, v51, v53
    v_max3_u32 v33, v33, v55, v57
    v_max3_u32 v33, v33, v59, v61
    v_cmp_ne_u32 s[30:31], s60, v32
    v_cmp_ne_u32 vcc, s60, v33
    s_or_b64 vcc, vcc, s[30:31]
    s_add_u32 s61, s61, 1
    s_cmp_gt_u32 s61, 200000
    s_cbranch_scc1 L_pd_182
    s_cbranch_vccz L_pd_182
    s_sleep 127
    s_branch L_gm_181
L_pd_182:
    v_add_f32 v50, v50, v54
    v_add_f32 v52, v52, v56
    v_add_f32 v50, v50, v58
    v_add_f32 v52, v52, v60
    v_cvt_pk_bf16_f32 v50, 0, v50
    v_cvt_pk_bf16_f32 v52, 0, v52
    v_lshrrev_b32 v38, 3, v0
    v_mul_u32_u24 v38, 2304, v38
    v_lshl_add_u32 v38, v34, 4, v38
    v_add_u32 v39, 18432, v38
    v_add_u32 v40, 36864, v38
    v_add_u32 v41, 55296, v38
    v_add_u32 v42, 73728, v38
    v_add_u32 v43, 92160, v38
    v_add_u32 v44, 110592, v38
    v_add_u32 v45, 129024, v38
    v_add_u32 v46, 147456, v38
    s_lshl_b32 s48, s80, 7
    s_add_u32 s83, s48, 542720
    s_mul_i32 s84, s97, 2304
    s_add_u32 s84, s84, s48
    s_add_u32 s84, s84, 229376
    s_add_u32 s82, s48, 524288
    v_and_b32 v34, 31, v0
    v_lshlrev_b32 v34, 3, v34
    s_lshl_b32 s30, s97, 8
    s_add_u32 s30, s30, 4096
    buffer_load_dwordx2 v[36:37], v34, s[32:35], s30 offen sc1
    s_getreg_b32 s31, hwreg(HW_REG_XCC_ID, 0, 4)
    s_waitcnt vmcnt(0)
    v_cmp_ne_u32 vcc, s31, v36
    v_cmp_ne_u32 s[30:31], s60, v37
    s_or_b64 vcc, vcc, s[30:31]
    s_cmp_eq_u64 vcc, 0
    s_cselect_b32 s63, 1, 0
    s_branch L_wo
L_red_t:
    s_cmp_eq_u32 s87, 1
    s_cselect_b32 s42, 0, 1152
    s_cmp_eq_u32 s87, 1
    s_cbranch_scc1 L_nb_183
    s_barrier
L_nb_183:
    s_mov_b32 s61, s86
L_rp_184:
    buffer_load_dwordx4 v[128:131], v38, s[32:35], s82 offen sc1
    s_waitcnt vmcnt(0)
    v_xor_b32 v128, s88, v128
    v_xor_b32 v130, s88, v130
    v_or_b32 v32, v128, v130
    v_and_b32 v32, 0xff, v32
    v_cmp_ne_u32 vcc, 0, v32
    s_add_u32 s61, s61, 1
    s_cmp_gt_u32 s61, 200000
    s_cbranch_scc1 L_pd_185
    s_cbranch_vccnz L_rp_184
L_pd_185:
    v_permlane32_swap_b32 v128, v130
    v_permlane32_swap_b32 v129, v131
    v_add_f32 v128, v128, v130
    v_add_f32 v129, v129, v131
    s_nop 1
    v_permlane16_swap_b32 v128, v129
    v_add_f32 v128, v128, v129
    s_nop 1
    v_add_f32_dpp v128, v128, v128 row_ror:8 row_mask:0xf bank_mask:0xf
    v_fma_f32 v15, v128, v50, v14
    v_cvt_pk_bf16_f32 v15, 0, v15
    v_or_b32 v128, s89, v15
    s_mov_b32 exec_lo, 0x00ff00ff
    s_mov_b32 exec_hi, 0x00ff00ff
    s_cmp_eq_u32 s63, 1
    s_cbranch_scc1 L_ls_186
    buffer_store_dword v128, v13, s[32:35], s84 offen sc1
    s_branch L_le_187
L_ls_186:
    buffer_store_dword v128, v13, s[32:35], s84 offen
L_le_187:
    s_mov_b64 exec, -1
    s_and_b32 s56, s80, 7
    s_cmp_lg_u32 s56, s97
    s_cbranch_scc1 L_tend
    s_cmp_lg_u32 s80, 0
    s_cbranch_scc1 L_rend
    s_mov_b64 exec, 1
    v_mov_b32 v32, s60
    v_mov_b32 v33, 0
    buffer_store_dword v32, v33, s[32:35], 0 offen sc1
L_rend:
    s_mov_b64 exec, -1
    v_min_u32 v33, 8, v0
    v_lshlrev_b32 v33, 2, v33
    s_lshl_b32 s56, s97, 8
    s_add_u32 s56, s56, 6144
    s_mov_b32 s61, s86
L_cf_188:
    buffer_load_dword v128, v33, s[32:35], s56 offen sc1
    s_waitcnt vmcnt(0)
    v_cmp_ne_u32 vcc, s60, v128
    s_add_u32 s61, s61, 1
    s_cmp_gt_u32 s61, 200000
    s_cbranch_scc1 L_pd_189
    s_cbranch_vccnz L_cf_188
L_pd_189:
    s_mov_b32 s61, s86
L_rp_190:
    buffer_load_dwordx4 v[128:131], v38, s[32:35], s83 offen sc1
    buffer_load_dwordx4 v[132:135], v39, s[32:35], s83 offen sc1
    buffer_load_dwordx4 v[136:139], v40, s[32:35], s83 offen sc1
    buffer_load_dwordx4 v[140:143], v41, s[32:35], s83 offen sc1
    buffer_load_dwordx4 v[144:147], v42, s[32:35], s83 offen sc1
    buffer_load_dwordx4 v[148:151], v43, s[32:35], s83 offen sc1
    buffer_load_dwordx4 v[152:155], v44, s[32:35], s83 offen sc1
    buffer_load_dwordx4 v[156:159], v45, s[32:35], s83 offen sc1
    buffer_load_dwordx4 v[160:163], v46, s[32:35], s83 offen sc1
    s_waitcnt vmcnt(8)
    v_xor_b32 v128, s88, v128
    v_xor_b32 v130, s88, v130
    v_or_b32 v32, v128, v130
    s_waitcnt vmcnt(7)
    v_xor_b32 v132, s88, v132
    v_xor_b32 v134, s88, v134
    v_or3_b32 v32, v32, v132, v134
    v_pk_add_f32 v[128:129], v[128:129], v[132:133]
    v_pk_add_f32 v[130:131], v[130:131], v[134:135]
    s_waitcnt vmcnt(6)
    v_xor_b32 v136, s88, v136
    v_xor_b32 v138, s88, v138
    v_or3_b32 v32, v32, v136, v138
    v_pk_add_f32 v[128:129], v[128:129], v[136:137]
    v_pk_add_f32 v[130:131], v[130:131], v[138:139]
    s_waitcnt vmcnt(5)
    v_xor_b32 v140, s88, v140
    v_xor_b32 v142, s88, v142
    v_or3_b32 v32, v32, v140, v142
    v_pk_add_f32 v[128:129], v[128:129], v[140:141]
    v_pk_add_f32 v[130:131], v[130:131], v[142:143]
    s_waitcnt vmcnt(4)
    v_xor_b32 v144, s88, v144
    v_xor_b32 v146, s88, v146
    v_or3_b32 v32, v32, v144, v146
    v_pk_add_f32 v[128:129], v[128:129], v[144:145]
    v_pk_add_f32 v[130:131], v[130:131], v[146:147]
    s_waitcnt vmcnt(3)
    v_xor_b32 v148, s88, v148
    v_xor_b32 v150, s88, v150
    v_or3_b32 v32, v32, v148, v150
    v_pk_add_f32 v[128:129], v[128:129], v[148:149]
    v_pk_add_f32 v[130:131], v[130:131], v[150:151]
    s_waitcnt vmcnt(2)
    v_xor_b32 v152, s88, v152
    v_xor_b32 v154, s88, v154
    v_or3_b32 v32, v32, v152, v154
    v_pk_add_f32 v[128:129], v[128:129], v[152:153]
    v_pk_add_f32 v[130:131], v[130:131], v[154:155]
    s_waitcnt vmcnt(1)
    v_xor_b32 v156, s88, v156
    v_xor_b32 v158, s88, v158
    v_or3_b32 v32, v32, v156, v158
    v_pk_add_f32 v[128:129], v[128:129], v[156:157]
    v_pk_add_f32 v[130:131], v[130:131], v[158:159]
    s_waitcnt vmcnt(0)
    v_xor_b32 v160, s88, v160
    v_xor_b32 v162, s88, v162
    v_or3_b32 v32, v32, v160, v162
    v_pk_add_f32 v[128:129], v[128:129], v[160:161]
    v_pk_add_f32 v[130:131], v[130:131], v[162:163]
    v_and_b32 v32, 0xff, v32
    v_cmp_ne_u32 vcc, 0, v32
    s_add_u32 s61, s61, 1
    s_cmp_gt_u32 s61, 200000
    s_cbranch_scc1 L_pd_191
    s_cbranch_vccnz L_rp_190
L_pd_191:
    v_permlane32_swap_b32 v128, v130
    v_permlane32_swap_b32 v129, v131
    v_add_f32 v128, v128, v130
    v_add_f32 v129, v129, v131
    s_nop 1
    v_permlane16_swap_b32 v128, v129
    v_add_f32 v128, v128, v129
    s_nop 1
    v_add_f32_dpp v128, v128, v128 row_ror:8 row_mask:0xf bank_mask:0xf
    v_fma_f32 v128, v128, v52, v15
    v_cvt_pk_bf16_f32 v128, 0, v128
    s_mov_b32 exec_lo, 0x00ff00ff
    s_mov_b32 exec_hi, 0x00ff00ff
    buffer_store_short_d16_hi v128, v12, s[40:43], s81 offen
    s_mov_b64 exec, -1
    s_branch L_tend
L_wo:
    s_cmp_lg_u32 s3, 3
    s_cbranch_scc1 L_wo1
    s_mov_b32 s36, s12
    s_mov_b32 s37, s13
    s_mov_b32 s38, 4718592
    s_mov_b32 s39, 0x20000
    v_bfe_u32 v32, v0, 3, 1
    v_lshl_add_u32 v4, v1, 2, v32
    v_mul_u32_u24 v4, 9216, v4
    v_and_b32 v32, 7, v0
    v_lshl_add_u32 v4, v32, 4, v4
    s_lshl_b32 s48, s97, 2
    s_add_u32 s48, s48, s3
    s_mul_i32 s48, s48, 147456
    s_lshl_b32 s49, s98, 7
    s_add_u32 s48, s48, s49
    s_sub_u32 s48, s48, 1792
    s_add_u32 s49, s48, 0
    buffer_load_dwordx4 v[64:67], v4, s[36:39], s49 offen nt
    s_add_u32 s49, s48, 18432
    buffer_load_dwordx4 v[68:71], v4, s[36:39], s49 offen nt
    s_add_u32 s49, s48, 1152
    buffer_load_dwordx4 v[72:75], v4, s[36:39], s49 offen nt
    s_add_u32 s49, s48, 19584
    buffer_load_dwordx4 v[76:79], v4, s[36:39], s49 offen nt
    s_add_u32 s49, s48, 2304
    buffer_load_dwordx4 v[80:83], v4, s[36:39], s49 offen nt
    s_add_u32 s49, s48, 20736
    buffer_load_dwordx4 v[84:87], v4, s[36:39], s49 offen nt
    s_add_u32 s49, s48, 3456
    buffer_load_dwordx4 v[88:91], v4, s[36:39], s49 offen nt
    s_add_u32 s49, s48, 21888
    buffer_load_dwordx4 v[92:95], v4, s[36:39], s49 offen nt
    s_add_u32 s49, s48, 4608
    buffer_load_dwordx4 v[96:99], v4, s[36:39], s49 offen nt
    s_add_u32 s49, s48, 23040
    buffer_load_dwordx4 v[100:103], v4, s[36:39], s49 offen nt
    s_add_u32 s49, s48, 5760
    buffer_load_dwordx4 v[104:107], v4, s[36:39], s49 offen nt
    s_add_u32 s49, s48, 24192
    buffer_load_dwordx4 v[108:111], v4, s[36:39], s49 offen nt
    s_add_u32 s49, s48, 6912
    buffer_load_dwordx4 v[112:115], v4, s[36:39], s49 offen nt
    s_add_u32 s49, s48, 25344
    buffer_load_dwordx4 v[116:119], v4, s[36:39], s49 offen nt
    s_add_u32 s49, s48, 8064
    buffer_load_dwordx4 v[120:123], v4, s[36:39], s49 offen nt
    s_add_u32 s49, s48, 26496
    buffer_load_dwordx4 v[124:127], v4, s[36:39], s49 offen nt
L_wo1:
    v_bfe_u32 v32, v0, 3, 1
    v_mul_u32_u24 v32, 0x0202, v32
    v_add_u32 v32, 0x0100, v32
    v_or_b32 v33, 0x0c0c0000, v32
    v_lshlrev_b32 v32, 16, v32
    v_or_b32 v32, 0x0c0c, v32
    v_and_b32 v34, 1, v0
    v_cmp_eq_u32 vcc, 1, v34
    s_nop 1
    v_cndmask_b32 v32, v33, v32, vcc
    v_bfe_u32 v34, v0, 1, 2
    v_mov_b32 v33, 0x0c0c0c0c
    v_cmp_eq_u32 vcc, 0, v34
    s_nop 1
    v_cndmask_b32 v8, v33, v32, vcc
    v_cmp_eq_u32 vcc, 1, v34
    s_nop 1
    v_cndmask_b32 v9, v33, v32, vcc
    v_cmp_eq_u32 vcc, 2, v34
    s_nop 1
    v_cndmask_b32 v10, v33, v32, vcc
    v_cmp_eq_u32 vcc, 3, v34
    s_nop 1
    v_cndmask_b32 v11, v33, v32, vcc
    v_and_b32 v5, 1, v1
    v_lshlrev_b32 v5, 7, v5
    v_and_b32 v32, 7, v0
    v_lshl_add_u32 v5, v32, 4, v5
    v_lshrrev_b32 v32, 5, v0
    v_lshl_add_u32 v5, v32, 3, v5
    v_lshlrev_b32 v2, 5, v1
    v_bfe_u32 v32, v0, 3, 1
    v_lshl_add_u32 v7, v32, 22, v5
    v_lshrrev_b32 v32, 5, v0
    v_and_b32 v33, 31, v0
    v_and_b32 v3, 15, v0
    v_xor_b32 v3, v3, v32
    v_lshlrev_b32 v3, 4, v3
    v_lshlrev_b32 v4, 10, v32
    v_lshl_add_u32 v4, v33, 4, v4
    s_lshl_b32 s49, s3, 8
    v_lshl_add_u32 v6, v33, 1, v32
    v_lshl_add_u32 v6, v6, 2, s49
    v_lshl_add_u32 v2, v1, 6, s49
    s_lshl_b32 s49, s3, 10
    v_lshl_add_u32 v20, v0, 4, s49
    s_lshl_b32 s49, s3, 6
    v_lshl_add_u32 v22, v32, 5, s49
    v_and_b32 v21, 23, v0
    v_bfe_u32 v33, v0, 3, 1
    v_mul_u32_u24 v33, 40, v33
    v_add_u32 v21, v21, v33
    v_lshlrev_b32 v21, 4, v21
    v_lshl_add_u32 v21, v32, 3, v21
    s_lshl_b32 s52, s97, 2
    s_add_u32 s52, s52, s3
    s_lshr_b32 s48, s52, 1
    s_lshl_b32 s48, s48, 14
    s_and_b32 s49, s52, 1
    s_lshl_b32 s49, s49, 9
    s_add_u32 s48, s48, s49
    s_add_u32 s48, s48, 262144
    s_add_u32 s49, s48, 4096
    s_add_u32 s50, s49, 4096
    s_add_u32 s51, s50, 4096
    s_lshl_b32 s52, s52, 8
    s_add_u32 s52, s52, 8192
    s_mul_i32 s53, s97, 2304
    s_lshl_b32 s55, s98, 8
    s_add_u32 s53, s53, s55
    s_add_u32 s53, s53, 520704
    s_mov_b32 s91, 1
    s_branch L_sync0
L_woml:
    s_mov_b32 s61, s86
    s_cmp_lg_u32 s3, 0
    s_cbranch_scc1 L_syncb
    v_lshlrev_b32 v3, 4, v0
L_mp:
    buffer_load_dwordx4 v[128:131], v3, s[32:35], s52 offen sc1
    s_waitcnt vmcnt(0)
    v_min_u32 v32, v129, v131
    v_max_u32 v33, v129, v131
    v_cmp_ne_u32 s[30:31], s60, v32
    v_cmp_ne_u32 vcc, s60, v33
    s_or_b64 vcc, vcc, s[30:31]
    s_add_u32 s61, s61, 1
    s_cmp_gt_u32 s61, 200000
    s_cbranch_scc1 L_pd_192
    s_cbranch_vccz L_pd_192
    s_sleep 4
    s_branch L_mp
L_pd_192:
    v_mov_b32 v32, v128
    s_nop 1
    v_max_f32_dpp v32, v32, v32 quad_perm:[1,0,3,2] row_mask:0xf bank_mask:0xf
    s_nop 1
    v_max_f32_dpp v32, v32, v32 quad_perm:[2,3,0,1] row_mask:0xf bank_mask:0xf
    s_nop 1
    v_max_f32_dpp v32, v32, v32 row_half_mirror row_mask:0xf bank_mask:0xf
    s_nop 1
    v_max_f32_dpp v32, v32, v32 row_mirror row_mask:0xf bank_mask:0xf
    v_sub_f32 v128, v128, v32
    v_exp_f32 v128, v128
    s_nop 0
    v_mul_f32 v32, v128, v130
    s_nop 1
    v_add_f32_dpp v32, v32, v32 quad_perm:[1,0,3,2] row_mask:0xf bank_mask:0xf
    s_nop 1
    v_add_f32_dpp v32, v32, v32 quad_perm:[2,3,0,1] row_mask:0xf bank_mask:0xf
    s_nop 1
    v_add_f32_dpp v32, v32, v32 row_half_mirror row_mask:0xf bank_mask:0xf
    s_nop 1
    v_add_f32_dpp v32, v32, v32 row_mirror row_mask:0xf bank_mask:0xf
    v_rcp_f32 v32, v32
    s_nop 0
    v_mul_f32 v128, v128, v32
    v_and_b32 v32, 1, v0
    v_lshlrev_b32 v32, 5, v32
    v_lshl_add_u32 v32, v1, 6, v32
    v_bfe_u32 v33, v0, 1, 3
    v_lshl_add_u32 v32, v33, 2, v32
    ds_write_b32 v32, v128 offset:0
    s_waitcnt lgkmcnt(0)
    s_branch L_syncb
L_wo2:
    s_mov_b32 s61, s86
    ds_read_b128 v[160:163], v22 offset:0
    ds_read_b128 v[164:167], v22 offset:16
L_ap:
    buffer_load_dwordx4 v[128:131], v4, s[32:35], s48 offen offset:0 sc1
    buffer_load_dwordx4 v[132:135], v4, s[32:35], s48 offen offset:2048 sc1
    buffer_load_dwordx4 v[136:139], v4, s[32:35], s49 offen offset:0 sc1
    buffer_load_dwordx4 v[140:143], v4, s[32:35], s49 offen offset:2048 sc1
    buffer_load_dwordx4 v[144:147], v4, s[32:35], s50 offen offset:0 sc1
    buffer_load_dwordx4 v[148:151], v4, s[32:35], s50 offen offset:2048 sc1
    buffer_load_dwordx4 v[152:155], v4, s[32:35], s51 offen offset:0 sc1
    buffer_load_dwordx4 v[156:159], v4, s[32:35], s51 offen offset:2048 sc1
    s_waitcnt vmcnt(7) lgkmcnt(0)
    v_xor_b32 v128, s88, v128
    v_xor_b32 v130, s88, v130
    v_or_b32 v32, v128, v130
    v_pk_mul_f32 v[128:129], v[128:129], v[160:161] op_sel_hi:[1,0]
    v_pk_mul_f32 v[130:131], v[130:131], v[160:161] op_sel_hi:[1,0]
    s_waitcnt vmcnt(6)
    v_xor_b32 v132, s88, v132
    v_xor_b32 v134, s88, v134
    v_or3_b32 v32, v32, v132, v134
    v_pk_fma_f32 v[128:129], v[132:133], v[160:161], v[128:129] op_sel:[0,1,0] op_sel_hi:[1,1,1]
    v_pk_fma_f32 v[130:131], v[134:135], v[160:161], v[130:131] op_sel:[0,1,0] op_sel_hi:[1,1,1]
    s_waitcnt vmcnt(5)
    v_xor_b32 v136, s88, v136
    v_xor_b32 v138, s88, v138
    v_or3_b32 v32, v32, v136, v138
    v_pk_fma_f32 v[128:129], v[136:137], v[162:163], v[128:129] op_sel:[0,0,0] op_sel_hi:[1,0,1]
    v_pk_fma_f32 v[130:131], v[138:139], v[162:163], v[130:131] op_sel:[0,0,0] op_sel_hi:[1,0,1]
    s_waitcnt vmcnt(4)
    v_xor_b32 v140, s88, v140
    v_xor_b32 v142, s88, v142
    v_or3_b32 v32, v32, v140, v142
    v_pk_fma_f32 v[128:129], v[140:141], v[162:163], v[128:129] op_sel:[0,1,0] op_sel_hi:[1,1,1]
    v_pk_fma_f32 v[130:131], v[142:143], v[162:163], v[130:131] op_sel:[0,1,0] op_sel_hi:[1,1,1]
    s_waitcnt vmcnt(3)
    v_xor_b32 v144, s88, v144
    v_xor_b32 v146, s88, v146
    v_or3_b32 v32, v32, v144, v146
    v_pk_fma_f32 v[128:129], v[144:145], v[164:165], v[128:129] op_sel:[0,0,0] op_sel_hi:[1,0,1]
    v_pk_fma_f32 v[130:131], v[146:147], v[164:165], v[130:131] op_sel:[0,0,0] op_sel_hi:[1,0,1]
    s_waitcnt vmcnt(2)
    v_xor_b32 v148, s88, v148
    v_xor_b32 v150, s88, v150
    v_or3_b32 v32, v32, v148, v150
    v_pk_fma_f32 v[128:129], v[148:149], v[164:165], v[128:129] op_sel:[0,1,0] op_sel_hi:[1,1,1]
    v_pk_fma_f32 v[130:131], v[150:151], v[164:165], v[130:131] op_sel:[0,1,0] op_sel_hi:[1,1,1]
    s_waitcnt vmcnt(1)
    v_xor_b32 v152, s88, v152
    v_xor_b32 v154, s88, v154
    v_or3_b32 v32, v32, v152, v154
    v_pk_fma_f32 v[128:129], v[152:153], v[166:167], v[128:129] op_sel:[0,0,0] op_sel_hi:[1,0,1]
    v_pk_fma_f32 v[130:131], v[154:155], v[166:167], v[130:131] op_sel:[0,0,0] op_sel_hi:[1,0,1]
    s_waitcnt vmcnt(0)
    v_xor_b32 v156, s88, v156
    v_xor_b32 v158, s88, v158
    v_or3_b32 v32, v32, v156, v158
    v_pk_fma_f32 v[128:129], v[156:157], v[166:167], v[128:129] op_sel:[0,1,0] op_sel_hi:[1,1,1]
    v_pk_fma_f32 v[130:131], v[158:159], v[166:167], v[130:131] op_sel:[0,1,0] op_sel_hi:[1,1,1]
    v_and_b32 v32, 0xff, v32
    v_cmp_ne_u32 vcc, 0, v32
    s_add_u32 s61, s61, 1
    s_cmp_gt_u32 s61, 200000
    s_cbranch_scc1 L_pd_193
    s_cbranch_vccnz L_ap
L_pd_193:
    v_permlane32_swap_b32 v128, v130
    v_permlane32_swap_b32 v129, v131
    v_pk_add_f32 v[128:129], v[128:129], v[130:131]
    v_cvt_pk_bf16_f32 v128, v128, v129
    ds_write_b32 v6, v128 offset:512
    ds_read_b128 v[192:195], v2 offset:512
    ds_read_b128 v[196:199], v2 offset:528
    ds_read_b128 v[200:203], v2 offset:544
    ds_read_b128 v[204:207], v2 offset:560
    s_waitcnt lgkmcnt(3)
    v_perm_b32 v24, v192, v192, v8
    v_perm_b32 v25, v192, v192, v9
    v_perm_b32 v26, v192, v192, v10
    v_perm_b32 v27, v192, v192, v11
    v_perm_b32 v28, v193, v193, v8
    v_perm_b32 v29, v193, v193, v9
    v_perm_b32 v30, v193, v193, v10
    v_perm_b32 v31, v193, v193, v11
    v_mfma_f32_16x16x32_bf16 v[208:211], v[64:67], v[24:27], 0
    v_perm_b32 v24, v194, v194, v8
    v_perm_b32 v25, v194, v194, v9
    v_perm_b32 v26, v194, v194, v10
    v_perm_b32 v27, v194, v194, v11
    v_mfma_f32_16x16x32_bf16 v[208:211], v[68:71], v[28:31], v[208:211]
    v_perm_b32 v28, v195, v195, v8
    v_perm_b32 v29, v195, v195, v9
    v_perm_b32 v30, v195, v195, v10
    v_perm_b32 v31, v195, v195, v11
    v_mfma_f32_16x16x32_bf16 v[208:211], v[72:75], v[24:27], v[208:211]
    s_waitcnt lgkmcnt(2)
    v_perm_b32 v24, v196, v196, v8
    v_perm_b32 v25, v196, v196, v9
    v_perm_b32 v26, v196, v196, v10
    v_perm_b32 v27, v196, v196, v11
    v_mfma_f32_16x16x32_bf16 v[208:211], v[76:79], v[28:31], v[208:211]
    v_perm_b32 v28, v197, v197, v8
    v_perm_b32 v29, v197, v197, v9
    v_perm_b32 v30, v197, v197, v10
    v_perm_b32 v31, v197, v197, v11
    v_mfma_f32_16x16x32_bf16 v[208:211], v[80:83], v[24:27], v[208:211]
    v_perm_b32 v24, v198, v198, v8
    v_perm_b32 v25, v198, v198, v9
    v_perm_b32 v26, v198, v198, v10
    v_perm_b32 v27, v198, v198, v11
    v_mfma_f32_16x16x32_bf16 v[208:211], v[84:87], v[28:31], v[208:211]
    v_perm_b32 v28, v199, v199, v8
    v_perm_b32 v29, v199, v199, v9
    v_perm_b32 v30, v199, v199, v10
    v_perm_b32 v31, v199, v199, v11
    v_mfma_f32_16x16x32_bf16 v[208:211], v[88:91], v[24:27], v[208:211]
    s_waitcnt lgkmcnt(1)
    v_perm_b32 v24, v200, v200, v8
    v_perm_b32 v25, v200, v200, v9
    v_perm_b32 v26, v200, v200, v10
    v_perm_b32 v27, v200, v200, v11
    v_mfma_f32_16x16x32_bf16 v[208:211], v[92:95], v[28:31], v[208:211]
    v_perm_b32 v28, v201, v201, v8
    v_perm_b32 v29, v201, v201, v9
    v_perm_b32 v30, v201, v201, v10
    v_perm_b32 v31, v201, v201, v11
    v_mfma_f32_16x16x32_bf16 v[208:211], v[96:99], v[24:27], v[208:211]
    v_perm_b32 v24, v202, v202, v8
    v_perm_b32 v25, v202, v202, v9
    v_perm_b32 v26, v202, v202, v10
    v_perm_b32 v27, v202, v202, v11
    v_mfma_f32_16x16x32_bf16 v[208:211], v[100:103], v[28:31], v[208:211]
    v_perm_b32 v28, v203, v203, v8
    v_perm_b32 v29, v203, v203, v9
    v_perm_b32 v30, v203, v203, v10
    v_perm_b32 v31, v203, v203, v11
    v_mfma_f32_16x16x32_bf16 v[208:211], v[104:107], v[24:27], v[208:211]
    s_waitcnt lgkmcnt(0)
    v_perm_b32 v24, v204, v204, v8
    v_perm_b32 v25, v204, v204, v9
    v_perm_b32 v26, v204, v204, v10
    v_perm_b32 v27, v204, v204, v11
    v_mfma_f32_16x16x32_bf16 v[208:211], v[108:111], v[28:31], v[208:211]
    v_perm_b32 v28, v205, v205, v8
    v_perm_b32 v29, v205, v205, v9
    v_perm_b32 v30, v205, v205, v10
    v_perm_b32 v31, v205, v205, v11
    v_mfma_f32_16x16x32_bf16 v[208:211], v[112:115], v[24:27], v[208:211]
    v_perm_b32 v24, v206, v206, v8
    v_perm_b32 v25, v206, v206, v9
    v_perm_b32 v26, v206, v206, v10
    v_perm_b32 v27, v206, v206, v11
    v_mfma_f32_16x16x32_bf16 v[208:211], v[116:119], v[28:31], v[208:211]
    v_perm_b32 v28, v207, v207, v8
    v_perm_b32 v29, v207, v207, v9
    v_perm_b32 v30, v207, v207, v10
    v_perm_b32 v31, v207, v207, v11
    v_mfma_f32_16x16x32_bf16 v[208:211], v[120:123], v[24:27], v[208:211]
    s_nop 0
    v_mfma_f32_16x16x32_bf16 v[208:211], v[124:127], v[28:31], v[208:211]
    s_nop 7
    ds_write_b128 v20, v[208:211] offset:2176
    s_waitcnt lgkmcnt(0)
    s_cmp_eq_u32 s87, 1
    s_cbranch_scc1 L_nb_194
    s_barrier
L_nb_194:
    s_cmp_ge_u32 s3, 2
    s_cbranch_scc1 L_red_t
    s_cmp_lg_u32 s3, 0
    s_cbranch_scc1 L_tend
    ds_read_b64 v[128:129], v21 offset:2176
    ds_read_b64 v[130:131], v21 offset:3200
    ds_read_b64 v[132:133], v21 offset:4224
    ds_read_b64 v[134:135], v21 offset:5248
    s_waitcnt lgkmcnt(2)
    v_pk_add_f32 v[128:129], v[128:129], v[130:131]
    s_waitcnt lgkmcnt(0)
    v_pk_add_f32 v[132:133], v[132:133], v[134:135]
    v_pk_add_f32 v[128:129], v[128:129], v[132:133]
    s_nop 1
    v_add_f32_dpp v128, v128, v128 row_ror:8 row_mask:0xf bank_mask:0xf
    v_add_f32_dpp v129, v129, v129 row_ror:8 row_mask:0xf bank_mask:0xf
    v_bfi_b32 v128, v23, s60, v128
    s_mov_b32 exec_lo, 0x00ff00ff
    s_mov_b32 exec_hi, 0x00ff00ff
    buffer_store_dwordx2 v[128:129], v5, s[32:35], s53 offen sc1
    s_mov_b64 exec, -1
    s_waitcnt vmcnt(0)
    s_cmp_eq_u32 s87, 1
    s_cbranch_scc1 L_nb_195
    s_barrier
L_nb_195:
    s_branch L_tend
L_ffn:
    s_mul_i32 s54, s97, 9
    s_add_u32 s54, s54, s98
    s_sub_u32 s54, s54, 23
    s_mov_b32 s40, s18
    s_mov_b32 s41, s19
    s_mov_b32 s42, 5308416
    s_mov_b32 s43, 0x20000
    v_bfe_u32 v32, v0, 3, 1
    v_mul_u32_u24 v32, 0x0202, v32
    v_add_u32 v32, 0x0100, v32
    v_or_b32 v33, 0x0c0c0000, v32
    v_lshlrev_b32 v32, 16, v32
    v_or_b32 v32, 0x0c0c, v32
    v_and_b32 v34, 1, v0
    v_cmp_eq_u32 vcc, 1, v34
    s_nop 1
    v_cndmask_b32 v32, v33, v32, vcc
    v_bfe_u32 v34, v0, 1, 2
    v_mov_b32 v33, 0x0c0c0c0c
    v_cmp_eq_u32 vcc, 0, v34
    s_nop 1
    v_cndmask_b32 v8, v33, v32, vcc
    v_cmp_eq_u32 vcc, 1, v34
    s_nop 1
    v_cndmask_b32 v9, v33, v32, vcc
    v_cmp_eq_u32 vcc, 2, v34
    s_nop 1
    v_cndmask_b32 v10, v33, v32, vcc
    v_cmp_eq_u32 vcc, 3, v34
    s_nop 1
    v_cndmask_b32 v11, v33, v32, vcc
    v_and_b32 v5, 1, v1
    v_lshlrev_b32 v5, 7, v5
    v_and_b32 v32, 7, v0
    v_lshl_add_u32 v5, v32, 4, v5
    v_lshrrev_b32 v32, 5, v0
    v_lshl_add_u32 v5, v32, 3, v5
    v_lshlrev_b32 v2, 5, v1
    v_bfe_u32 v32, v0, 3, 1
    v_lshl_add_u32 v7, v32, 22, v5
    v_lshrrev_b32 v20, 2, v0
    v_lshlrev_b32 v20, 7, v20
    v_bfe_u32 v32, v0, 3, 2
    v_xor_b32 v32, s3, v32
    v_lshl_add_u32 v20, v32, 5, v20
    v_and_b32 v32, 3, v0
    v_lshl_add_u32 v20, v32, 3, v20
    v_add_u32 v20, 72192, v20
    v_add_u32 v21, 36864, v20
    v_lshlrev_b32 v3, 4, v1
    s_lshl_b32 s49, s3, 3
    v_add_u32 v22, s49, v2
    s_cmp_eq_u32 s3, 3
    s_cbranch_scc1 L_ffg
    v_bfe_u32 v32, v0, 3, 1
    v_lshl_add_u32 v6, v1, 2, v32
    v_mul_u32_u24 v6, 1152, v6
    v_and_b32 v32, 7, v0
    v_lshl_add_u32 v6, v32, 4, v6
    s_mul_i32 s56, s54, 73728
    s_mul_i32 s49, s3, 384
    s_add_u32 s56, s56, s49
    s_mul_i32 s48, s54, 2304
    s_mul_i32 s49, s3, 768
    s_add_u32 s48, s48, s49
    s_add_u32 s48, s48, 542720
    s_mov_b32 s91, 2
L_sync0:
    s_mov_b32 s85, 0
    s_mov_b32 s87, 1
    s_mov_b32 s86, 200000
    s_mov_b32 s34, 0
    s_setprio 0
L_sync:
    s_waitcnt vmcnt(0)
    s_cmp_eq_u32 s3, 1
    s_cbranch_scc1 L_comb
    s_mov_b32 s90, 0
    s_cmp_eq_u32 s87, 1
    s_cbranch_scc1 L_nb_196
    s_barrier
L_nb_196:
    s_branch L_synca
L_comb:
    s_mov_b32 s90, 1
    v_and_b32 v34, 31, v0
    v_lshlrev_b32 v34, 3, v34
    s_lshl_b32 s30, s97, 8
    s_add_u32 s30, s30, 4096
    buffer_load_dwordx2 v[36:37], v34, s[32:35], s30 offen sc1
    v_lshlrev_b32 v248, 4, v0
    v_lshlrev_b32 v249, 3, v0
    v_bfe_u32 v251, v0, 3, 1
    v_lshlrev_b32 v250, 9, v251
    v_lshl_add_u32 v250, v1, 7, v250
    v_and_b32 v252, 7, v0
    v_lshl_add_u32 v250, v252, 4, v250
    v_lshlrev_b32 v251, 8, v251
    s_lshl_b32 s57, s99, 10
    s_add_u32 s57, s57, 262144
    s_lshr_b32 s58, s99, 4
    s_lshl_b32 s58, s58, 9
    s_and_b32 s59, s99, 15
    s_lshl_b32 s59, s59, 4
    s_add_u32 s58, s58, s59
    s_add_u32 s58, s58, 8192
    v_mov_b32 v209, s60
    v_mov_b32 v211, s60
    s_getreg_b32 s31, hwreg(HW_REG_XCC_ID, 0, 4)
    s_waitcnt vmcnt(0)
    v_cmp_ne_u32 vcc, s31, v36
    v_cmp_ne_u32 s[30:31], s60, v37
    s_or_b64 vcc, vcc, s[30:31]
    s_cmp_eq_u64 vcc, 0
    s_cselect_b32 s63, 1, 0
    s_cmp_eq_u32 s87, 1
    s_cbranch_scc1 L_nb_197
    s_barrier
L_nb_197:
    buffer_load_dwordx4 v[244:247], v250, s[32:35], s57 offen sc1
    buffer_load_dword v253, v251, s[32:35], s58 offen sc1
    ds_read_b64 v[236:237], v249 offset:6656
    ds_read_b64 v[238:239], v249 offset:7168
    ds_read_b64 v[240:241], v249 offset:7680
    ds_read_b64 v[242:243], v249 offset:8192
    s_waitcnt lgkmcnt(0)
    v_min3_f32 v208, v236, v238, v240
    v_min_f32 v208, v208, v242
    v_sub_f32 v236, v208, v236
    v_sub_f32 v238, v208, v238
    v_sub_f32 v240, v208, v240
    v_sub_f32 v242, v208, v242
    v_exp_f32 v236, v236
    v_exp_f32 v238, v238
    v_exp_f32 v240, v240
    v_exp_f32 v242, v242
    v_mul_f32 v208, -1.0, v208
    v_mul_f32 v210, v236, v237
    v_fmac_f32 v210, v238, v239
    v_fmac_f32 v210, v240, v241
    v_fmac_f32 v210, v242, v243
    s_nop 1
    v_add_f32_dpp v210, v210, v210 quad_perm:[1,0,3,2] row_mask:0xf bank_mask:0xf
    s_nop 1
    v_add_f32_dpp v210, v210, v210 quad_perm:[2,3,0,1] row_mask:0xf bank_mask:0xf
    s_nop 1
    v_add_f32_dpp v210, v210, v210 row_half_mirror row_mask:0xf bank_mask:0xf
    v_mov_b32 v252, v210
    s_nop 1
    v_permlane16_swap_b32 v210, v252
    v_add_f32 v210, v210, v252
    v_mov_b32 v252, v210
    s_nop 1
    v_permlane32_swap_b32 v210, v252
    v_add_f32 v210, v210, v252
    s_mov_b64 exec, 0x101
    s_cmp_eq_u32 s63, 1
    s_cbranch_scc1 L_ls_198
    buffer_store_dwordx4 v[208:211], v251, s[32:35], s58 offen sc1
    s_branch L_le_199
L_ls_198:
    buffer_store_dwordx4 v[208:211], v251, s[32:35], s58 offen
L_le_199:
    s_mov_b64 exec, -1
L_synca:
    s_cmp_eq_u32 s91, 1
    s_cbranch_scc1 L_woml
L_syncb:
    s_waitcnt vmcnt(0)
    s_cmp_eq_u32 s87, 1
    s_cbranch_scc1 L_nb_200
    s_barrier
L_nb_200:
    s_cmp_eq_u32 s90, 0
    s_cbranch_scc1 L_sync2
    ds_read_b128 v[220:223], v248 offset:2176
    ds_read_b128 v[224:227], v248 offset:3200
    ds_read_b128 v[228:231], v248 offset:4224
    ds_read_b128 v[232:235], v248 offset:5248
    s_waitcnt lgkmcnt(3)
    v_pk_mul_f32 v[244:245], v[220:221], v[236:237] op_sel_hi:[1,0]
    v_pk_mul_f32 v[246:247], v[222:223], v[236:237] op_sel_hi:[1,0]
    s_waitcnt lgkmcnt(2)
    v_pk_fma_f32 v[244:245], v[224:225], v[238:239], v[244:245] op_sel_hi:[1,0,1]
    v_pk_fma_f32 v[246:247], v[226:227], v[238:239], v[246:247] op_sel_hi:[1,0,1]
    s_waitcnt lgkmcnt(1)
    v_pk_fma_f32 v[244:245], v[228:229], v[240:241], v[244:245] op_sel_hi:[1,0,1]
    v_pk_fma_f32 v[246:247], v[230:231], v[240:241], v[246:247] op_sel_hi:[1,0,1]
    s_waitcnt lgkmcnt(0)
    v_pk_fma_f32 v[244:245], v[232:233], v[242:243], v[244:245] op_sel_hi:[1,0,1]
    v_pk_fma_f32 v[246:247], v[234:235], v[242:243], v[246:247] op_sel_hi:[1,0,1]
    v_bfi_b32 v244, v23, s60, v244
    v_bfi_b32 v246, v23, s60, v246
    s_cmp_eq_u32 s63, 1
    s_cbranch_scc1 L_ls_201
    buffer_store_dwordx4 v[244:247], v250, s[32:35], s57 offen sc1
    s_branch L_le_202
L_ls_201:
    buffer_store_dwordx4 v[244:247], v250, s[32:35], s57 offen
L_le_202:
L_sync2:
    s_cmp_eq_u32 s87, 1
    s_cbranch_scc1 L_nb_203
    s_barrier
L_nb_203:
    s_cmp_eq_u32 s91, 0
    s_cbranch_scc1 L_l2p
    s_cmp_eq_u32 s91, 1
    s_cbranch_scc1 L_wo2
    s_cmp_eq_u32 s87, 1
    s_cbranch_scc1 L_sd_204
    s_mov_b32 s36, s16
    s_mov_b32 s37, s17
    s_mov_b32 s38, 5308416
    s_mov_b32 s39, 0x20000
    v_lshrrev_b32 v4, 3, v0
    v_mul_u32_u24 v4, 9216, v4
    v_and_b32 v32, 7, v0
    v_lshlrev_b32 v33, 1, v1
    v_xor_b32 v32, v32, v33
    v_lshl_add_u32 v4, v32, 4, v4
    s_mul_i32 s51, s3, 1769472
    s_lshl_b32 s49, s54, 7
    s_add_u32 s51, s51, s49
    s_add_u32 s51, s51, 0
    s_mul_i32 s55, s3, 24576
    s_add_u32 m0, s55, 72192
    s_nop 0
    buffer_load_dwordx4 v4, s[36:39], s51 offen nt lds
    s_add_u32 m0, m0, 1024
    s_add_u32 s51, s51, 73728
    buffer_load_dwordx4 v4, s[36:39], s51 offen nt lds
    s_add_u32 m0, m0, 1024
    s_add_u32 s51, s51, 73728
    buffer_load_dwordx4 v4, s[36:39], s51 offen nt lds
    s_add_u32 m0, m0, 1024
    s_add_u32 s51, s51, 73728
    buffer_load_dwordx4 v4, s[36:39], s51 offen nt lds
    s_add_u32 m0, m0, 1024
    s_add_u32 s51, s51, 73728
    buffer_load_dwordx4 v4, s[36:39], s51 offen nt lds
    s_add_u32 m0, m0, 1024
    s_add_u32 s51, s51, 73728
    buffer_load_dwordx4 v4, s[36:39], s51 offen nt lds
    s_add_u32 m0, m0, 1024
    s_add_u32 s51, s51, 73728
    buffer_load_dwordx4 v4, s[36:39], s51 offen nt lds
    s_add_u32 m0, m0, 1024
    s_add_u32 s51, s51, 73728
    buffer_load_dwordx4 v4, s[36:39], s51 offen nt lds
    s_add_u32 m0, m0, 1024
    s_add_u32 s51, s51, 73728
    buffer_load_dwordx4 v4, s[36:39], s51 offen nt lds
    s_add_u32 m0, m0, 1024
    s_add_u32 s51, s51, 73728
    buffer_load_dwordx4 v4, s[36:39], s51 offen nt lds
    s_add_u32 m0, m0, 1024
    s_add_u32 s51, s51, 73728
    buffer_load_dwordx4 v4, s[36:39], s51 offen nt lds
    s_add_u32 m0, m0, 1024
    s_add_u32 s51, s51, 73728
    buffer_load_dwordx4 v4, s[36:39], s51 offen nt lds
    s_add_u32 m0, m0, 1024
    s_add_u32 s51, s51, 73728
    buffer_load_dwordx4 v4, s[36:39], s51 offen nt lds
    s_add_u32 m0, m0, 1024
    s_add_u32 s51, s51, 73728
    buffer_load_dwordx4 v4, s[36:39], s51 offen nt lds
    s_add_u32 m0, m0, 1024
    s_add_u32 s51, s51, 73728
    buffer_load_dwordx4 v4, s[36:39], s51 offen nt lds
    s_add_u32 m0, m0, 1024
    s_add_u32 s51, s51, 73728
    buffer_load_dwordx4 v4, s[36:39], s51 offen nt lds
    s_add_u32 m0, m0, 1024
    s_add_u32 s51, s51, 73728
    buffer_load_dwordx4 v4, s[36:39], s51 offen nt lds
    s_add_u32 m0, m0, 1024
    s_add_u32 s51, s51, 73728
    buffer_load_dwordx4 v4, s[36:39], s51 offen nt lds
    s_add_u32 m0, m0, 1024
    s_add_u32 s51, s51, 73728
    buffer_load_dwordx4 v4, s[36:39], s51 offen nt lds
    s_add_u32 m0, m0, 1024
    s_add_u32 s51, s51, 73728
    buffer_load_dwordx4 v4, s[36:39], s51 offen nt lds
    s_add_u32 m0, m0, 1024
    s_add_u32 s51, s51, 73728
    buffer_load_dwordx4 v4, s[36:39], s51 offen nt lds
    s_add_u32 m0, m0, 1024
    s_add_u32 s51, s51, 73728
    buffer_load_dwordx4 v4, s[36:39], s51 offen nt lds
    s_add_u32 m0, m0, 1024
    s_add_u32 s51, s51, 73728
    buffer_load_dwordx4 v4, s[36:39], s51 offen nt lds
    s_add_u32 m0, m0, 1024
    s_add_u32 s51, s51, 73728
    buffer_load_dwordx4 v4, s[36:39], s51 offen nt lds
    s_add_u32 s49, s56, 0
    buffer_load_dwordx4 v[112:115], v6, s[40:43], s49 offen offset:0 nt
    buffer_load_dwordx4 v[116:119], v6, s[40:43], s49 offen offset:128 nt
    buffer_load_dwordx4 v[120:123], v6, s[40:43], s49 offen offset:256 nt
    s_add_u32 s49, s56, 2304
    buffer_load_dwordx4 v[124:127], v6, s[40:43], s49 offen offset:0 nt
    buffer_load_dwordx4 v[128:131], v6, s[40:43], s49 offen offset:128 nt
    buffer_load_dwordx4 v[132:135], v6, s[40:43], s49 offen offset:256 nt
    s_add_u32 s49, s56, 18432
    buffer_load_dwordx4 v[136:139], v6, s[40:43], s49 offen offset:0 nt
    buffer_load_dwordx4 v[140:143], v6, s[40:43], s49 offen offset:128 nt
    buffer_load_dwordx4 v[144:147], v6, s[40:43], s49 offen offset:256 nt
    s_add_u32 s49, s56, 20736
    buffer_load_dwordx4 v[148:151], v6, s[40:43], s49 offen offset:0 nt
    buffer_load_dwordx4 v[152:155], v6, s[40:43], s49 offen offset:128 nt
    buffer_load_dwordx4 v[156:159], v6, s[40:43], s49 offen offset:256 nt
L_sd_204:
    s_waitcnt vmcnt(12)
    s_cmp_eq_u32 s87, 1
    s_cbranch_scc1 L_nb_205
    s_barrier
L_nb_205:
    ds_read_b64_tr_b16 v[40:41], v20 offset:0
    ds_read_b64_tr_b16 v[42:43], v20 offset:2048
    ds_read_b64_tr_b16 v[44:45], v20 offset:4096
    ds_read_b64_tr_b16 v[46:47], v20 offset:6144
    ds_read_b64_tr_b16 v[48:49], v20 offset:8192
    ds_read_b64_tr_b16 v[50:51], v20 offset:10240
    ds_read_b64_tr_b16 v[52:53], v20 offset:12288
    ds_read_b64_tr_b16 v[54:55], v20 offset:14336
    ds_read_b64_tr_b16 v[56:57], v20 offset:16384
    ds_read_b64_tr_b16 v[58:59], v20 offset:18432
    ds_read_b64_tr_b16 v[60:61], v20 offset:20480
    ds_read_b64_tr_b16 v[62:63], v20 offset:22528
    ds_read_b64_tr_b16 v[64:65], v20 offset:24576
    ds_read_b64_tr_b16 v[66:67], v20 offset:26624
    ds_read_b64_tr_b16 v[68:69], v20 offset:28672
    ds_read_b64_tr_b16 v[70:71], v20 offset:30720
    ds_read_b64_tr_b16 v[72:73], v20 offset:32768
    ds_read_b64_tr_b16 v[74:75], v20 offset:34816
    ds_read_b64_tr_b16 v[76:77], v21 offset:0
    ds_read_b64_tr_b16 v[78:79], v21 offset:2048
    ds_read_b64_tr_b16 v[80:81], v21 offset:4096
    ds_read_b64_tr_b16 v[82:83], v21 offset:6144
    ds_read_b64_tr_b16 v[84:85], v21 offset:8192
    ds_read_b64_tr_b16 v[86:87], v21 offset:10240
    ds_read_b64_tr_b16 v[88:89], v21 offset:12288
    ds_read_b64_tr_b16 v[90:91], v21 offset:14336
    ds_read_b64_tr_b16 v[92:93], v21 offset:16384
    ds_read_b64_tr_b16 v[94:95], v21 offset:18432
    ds_read_b64_tr_b16 v[96:97], v21 offset:20480
    ds_read_b64_tr_b16 v[98:99], v21 offset:22528
    ds_read_b64_tr_b16 v[100:101], v21 offset:24576
    ds_read_b64_tr_b16 v[102:103], v21 offset:26624
    ds_read_b64_tr_b16 v[104:105], v21 offset:28672
    ds_read_b64_tr_b16 v[106:107], v21 offset:30720
    ds_read_b64_tr_b16 v[108:109], v21 offset:32768
    ds_read_b64_tr_b16 v[110:111], v21 offset:34816
    s_waitcnt vmcnt(0) lgkmcnt(0)
    s_cmp_eq_u32 s87, 1
    s_cbranch_scc1 L_nb_206
    s_barrier
L_nb_206:
    s_cmp_eq_u32 s87, 1
    s_cbranch_scc1 L_sd_207
    s_add_u32 s49, s56, 36864
    buffer_load_dwordx4 v[160:163], v6, s[40:43], s49 offen offset:0 nt
    buffer_load_dwordx4 v[164:167], v6, s[40:43], s49 offen offset:128 nt
    buffer_load_dwordx4 v[168:171], v6, s[40:43], s49 offen offset:256 nt
    s_add_u32 s49, s56, 39168
    buffer_load_dwordx4 v[172:175], v6, s[40:43], s49 offen offset:0 nt
    buffer_load_dwordx4 v[176:179], v6, s[40:43], s49 offen offset:128 nt
    buffer_load_dwordx4 v[180:183], v6, s[40:43], s49 offen offset:256 nt
    s_add_u32 s49, s56, 55296
    buffer_load_dwordx4 v[184:187], v6, s[40:43], s49 offen offset:0 nt
    buffer_load_dwordx4 v[188:191], v6, s[40:43], s49 offen offset:128 nt
    buffer_load_dwordx4 v[192:195], v6, s[40:43], s49 offen offset:256 nt
    s_add_u32 s49, s56, 57600
    buffer_load_dwordx4 v[196:199], v6, s[40:43], s49 offen offset:0 nt
    buffer_load_dwordx4 v[200:203], v6, s[40:43], s49 offen offset:128 nt
    buffer_load_dwordx4 v[204:207], v6, s[40:43], s49 offen offset:256 nt
L_sd_207:
    s_cmp_eq_u32 s87, 1
    s_cbranch_scc1 L_nb_208
    s_barrier
L_nb_208:
    ds_read_b128 v[220:223], v3 offset:512
    ds_read_b128 v[224:227], v3 offset:576
    ds_read_b128 v[228:231], v3 offset:640
    ds_read_b128 v[232:235], v3 offset:704
    ds_read_b128 v[236:239], v3 offset:768
    ds_read_b128 v[240:243], v3 offset:832
    ds_read_b128 v[244:247], v3 offset:896
    ds_read_b128 v[248:251], v3 offset:960
    ds_read_b128 v[252:255], v3 offset:1024
    s_waitcnt lgkmcnt(8)
    v_mfma_f32_16x16x32_bf16 v[208:211], v[40:43], v[220:223], 0
    ds_read_b128 v[220:223], v3 offset:1088
    s_waitcnt lgkmcnt(8)
    v_mfma_f32_16x16x32_bf16 v[208:211], v[44:47], v[224:227], v[208:211]
    ds_read_b128 v[224:227], v3 offset:1152
    s_waitcnt lgkmcnt(8)
    v_mfma_f32_16x16x32_bf16 v[208:211], v[48:51], v[228:231], v[208:211]
    ds_read_b128 v[228:231], v3 offset:1216
    s_waitcnt lgkmcnt(8)
    v_mfma_f32_16x16x32_bf16 v[208:211], v[52:55], v[232:235], v[208:211]
    ds_read_b128 v[232:235], v3 offset:1280
    s_waitcnt lgkmcnt(8)
    v_mfma_f32_16x16x32_bf16 v[208:211], v[56:59], v[236:239], v[208:211]
    ds_read_b128 v[236:239], v3 offset:1344
    s_waitcnt lgkmcnt(8)
    v_mfma_f32_16x16x32_bf16 v[208:211], v[60:63], v[240:243], v[208:211]
    ds_read_b128 v[240:243], v3 offset:1408
    s_waitcnt lgkmcnt(8)
    v_mfma_f32_16x16x32_bf16 v[208:211], v[64:67], v[244:247], v[208:211]
    ds_read_b128 v[244:247], v3 offset:1472
    s_waitcnt lgkmcnt(8)
    v_mfma_f32_16x16x32_bf16 v[208:211], v[68:71], v[248:251], v[208:211]
    ds_read_b128 v[248:251], v3 offset:1536
    s_waitcnt lgkmcnt(8)
    v_mfma_f32_16x16x32_bf16 v[208:211], v[72:75], v[252:255], v[208:211]
    ds_read_b128 v[252:255], v3 offset:1600
    s_waitcnt lgkmcnt(8)
    v_mfma_f32_16x16x32_bf16 v[208:211], v[76:79], v[220:223], v[208:211]
    s_waitcnt lgkmcnt(7)
    v_mfma_f32_16x16x32_bf16 v[208:211], v[80:83], v[224:227], v[208:211]
    s_waitcnt lgkmcnt(6)
    v_mfma_f32_16x16x32_bf16 v[208:211], v[84:87], v[228:231], v[208:211]
    s_waitcnt lgkmcnt(5)
    v_mfma_f32_16x16x32_bf16 v[208:211], v[88:91], v[232:235], v[208:211]
    s_waitcnt lgkmcnt(4)
    v_mfma_f32_16x16x32_bf16 v[208:211], v[92:95], v[236:239], v[208:211]
    s_waitcnt lgkmcnt(3)
    v_mfma_f32_16x16x32_bf16 v[208:211], v[96:99], v[240:243], v[208:211]
    s_waitcnt lgkmcnt(2)
    v_mfma_f32_16x16x32_bf16 v[208:211], v[100:103], v[244:247], v[208:211]
    s_waitcnt lgkmcnt(1)
    v_mfma_f32_16x16x32_bf16 v[208:211], v[104:107], v[248:251], v[208:211]
    s_waitcnt lgkmcnt(0)
    v_mfma_f32_16x16x32_bf16 v[208:211], v[108:111], v[252:255], v[208:211]
    s_nop 7
    v_max_f32 v208, 0, v208
    v_max_f32 v209, 0, v209
    v_max_f32 v210, 0, v210
    v_max_f32 v211, 0, v211
    v_cvt_pk_bf16_f32 v212, v208, v209
    v_cvt_pk_bf16_f32 v213, v210, v211
    s_mov_b32 exec_lo, 0x00010001
    s_mov_b32 exec_hi, 0x00010001
    ds_write_b64 v22, v[212:213] offset:6272
    s_mov_b64 exec, -1
    s_waitcnt lgkmcnt(0)
    s_cmp_eq_u32 s87, 1
    s_cbranch_scc1 L_nb_209
    s_barrier
L_nb_209:
    s_waitcnt vmcnt(0)
    ds_read_b128 v[12:15], v2 offset:6272
    ds_read_b128 v[16:19], v2 offset:6288
    s_waitcnt lgkmcnt(1)
    v_perm_b32 v220, v12, v12, v8
    v_perm_b32 v221, v12, v12, v9
    v_perm_b32 v222, v12, v12, v10
    v_perm_b32 v223, v12, v12, v11
    v_perm_b32 v224, v13, v13, v8
    v_perm_b32 v225, v13, v13, v9
    v_perm_b32 v226, v13, v13, v10
    v_perm_b32 v227, v13, v13, v11
    v_mfma_f32_16x16x32_bf16 v[208:211], v[112:115], v[220:223], 0
    v_mfma_f32_16x16x32_bf16 v[212:215], v[116:119], v[220:223], 0
    v_perm_b32 v228, v14, v14, v8
    v_perm_b32 v229, v14, v14, v9
    v_perm_b32 v230, v14, v14, v10
    v_perm_b32 v231, v14, v14, v11
    v_mfma_f32_16x16x32_bf16 v[208:211], v[124:127], v[224:227], v[208:211]
    v_mfma_f32_16x16x32_bf16 v[212:215], v[128:131], v[224:227], v[212:215]
    v_perm_b32 v232, v15, v15, v8
    v_perm_b32 v233, v15, v15, v9
    v_perm_b32 v234, v15, v15, v10
    v_perm_b32 v235, v15, v15, v11
    v_mfma_f32_16x16x32_bf16 v[208:211], v[136:139], v[228:231], v[208:211]
    v_mfma_f32_16x16x32_bf16 v[212:215], v[140:143], v[228:231], v[212:215]
    s_waitcnt lgkmcnt(0)
    v_perm_b32 v236, v16, v16, v8
    v_perm_b32 v237, v16, v16, v9
    v_perm_b32 v238, v16, v16, v10
    v_perm_b32 v239, v16, v16, v11
    v_mfma_f32_16x16x32_bf16 v[208:211], v[148:151], v[232:235], v[208:211]
    v_mfma_f32_16x16x32_bf16 v[212:215], v[152:155], v[232:235], v[212:215]
    v_perm_b32 v240, v17, v17, v8
    v_perm_b32 v241, v17, v17, v9
    v_perm_b32 v242, v17, v17, v10
    v_perm_b32 v243, v17, v17, v11
    v_mfma_f32_16x16x32_bf16 v[208:211], v[160:163], v[236:239], v[208:211]
    v_mfma_f32_16x16x32_bf16 v[212:215], v[164:167], v[236:239], v[212:215]
    v_perm_b32 v244, v18, v18, v8
    v_perm_b32 v245, v18, v18, v9
    v_perm_b32 v246, v18, v18, v10
    v_perm_b32 v247, v18, v18, v11
    v_mfma_f32_16x16x32_bf16 v[208:211], v[172:175], v[240:243], v[208:211]
    v_mfma_f32_16x16x32_bf16 v[212:215], v[176:179], v[240:243], v[212:215]
    v_perm_b32 v248, v19, v19, v8
    v_perm_b32 v249, v19, v19, v9
    v_perm_b32 v250, v19, v19, v10
    v_perm_b32 v251, v19, v19, v11
    v_mfma_f32_16x16x32_bf16 v[208:211], v[184:187], v[244:247], v[208:211]
    v_mfma_f32_16x16x32_bf16 v[212:215], v[188:191], v[244:247], v[212:215]
    v_mfma_f32_16x16x32_bf16 v[208:211], v[196:199], v[248:251], v[208:211]
    v_mfma_f32_16x16x32_bf16 v[212:215], v[200:203], v[248:251], v[212:215]
    v_mfma_f32_16x16x32_bf16 v[216:219], v[120:123], v[220:223], 0
    v_mfma_f32_16x16x32_bf16 v[216:219], v[132:135], v[224:227], v[216:219]
    v_mfma_f32_16x16x32_bf16 v[216:219], v[144:147], v[228:231], v[216:219]
    v_mfma_f32_16x16x32_bf16 v[216:219], v[156:159], v[232:235], v[216:219]
    v_mfma_f32_16x16x32_bf16 v[216:219], v[168:171], v[236:239], v[216:219]
    v_mfma_f32_16x16x32_bf16 v[216:219], v[180:183], v[240:243], v[216:219]
    v_mfma_f32_16x16x32_bf16 v[216:219], v[192:195], v[244:247], v[216:219]
    v_permlane32_swap_b32 v208, v210
    v_permlane32_swap_b32 v209, v211
    v_permlane32_swap_b32 v212, v214
    v_permlane32_swap_b32 v213, v215
    v_add_f32_dpp v208, v210, v208 row_ror:8 row_mask:0xf bank_mask:0xf
    v_add_f32_dpp v209, v211, v209 row_ror:8 row_mask:0xf bank_mask:0xf
    v_mfma_f32_16x16x32_bf16 v[216:219], v[204:207], v[248:251], v[216:219]
    v_add_f32_dpp v212, v214, v212 row_ror:8 row_mask:0xf bank_mask:0xf
    v_add_f32_dpp v213, v215, v213 row_ror:8 row_mask:0xf bank_mask:0xf
    v_bfi_b32 v208, v23, s60, v208
    buffer_store_dwordx2 v[208:209], v7, s[32:35], s48 offen offset:0 sc1
    v_bfi_b32 v212, v23, s60, v212
    buffer_store_dwordx2 v[212:213], v7, s[32:35], s48 offen offset:256 sc1
    s_nop 1
    v_permlane32_swap_b32 v216, v218
    v_permlane32_swap_b32 v217, v219
    s_nop 0
    v_add_f32_dpp v216, v218, v216 row_ror:8 row_mask:0xf bank_mask:0xf
    v_add_f32_dpp v217, v219, v217 row_ror:8 row_mask:0xf bank_mask:0xf
    v_bfi_b32 v216, v23, s60, v216
    buffer_store_dwordx2 v[216:217], v7, s[32:35], s48 offen offset:512 sc1
    s_cmp_eq_u32 s90, 0
    s_cbranch_scc1 L_nofl
    s_lshl_b32 s30, s97, 8
    s_lshl_b32 s31, s98, 2
    s_add_u32 s30, s30, s31
    s_add_u32 s30, s30, 6052
    v_mov_b32 v32, s60
    v_mov_b32 v33, 0
    s_mov_b64 exec, 1
    s_cmp_eq_u32 s63, 1
    s_cbranch_scc1 L_ls_210
    buffer_store_dword v32, v33, s[32:35], s30 offen sc1
    s_branch L_le_211
L_ls_210:
    buffer_store_dword v32, v33, s[32:35], s30 offen
L_le_211:
    s_mov_b64 exec, -1
L_nofl:
    s_branch L_tend
L_ffg:
    v_and_b32 v7, 48, v0
    v_and_b32 v160, 7, v0
    v_lshl_add_u32 v7, v160, 1, v7
    v_bfe_u32 v160, v0, 3, 1
    v_add_lshl_u32 v7, v7, v160, 3
    s_mov_b32 s44, 30208
    s_mov_b32 s45, 34304
    s_mov_b32 s46, 38400
    s_mov_b32 s47, 57856
    s_mov_b32 s48, 61952
    s_mov_b32 s49, 66048
    s_mov_b32 s50, 85504
    s_mov_b32 s51, 89600
    s_mov_b32 s52, 93696
    s_mov_b32 s61, 0
L_gm_212:
    buffer_load_dwordx2 v[40:41], v7, s[32:35], s52 offen offset:512 sc1
    s_waitcnt vmcnt(0)
    v_cmp_ne_u32 vcc, s60, v41
    s_add_u32 s61, s61, 1
    s_cmp_gt_u32 s61, 200000
    s_cbranch_scc1 L_pd_213
    s_cbranch_vccz L_pd_213
    s_sleep 127
    s_branch L_gm_212
L_pd_213:
    s_mov_b32 s61, 0
L_gm_214:
    buffer_load_dwordx2 v[40:41], v7, s[32:35], s44 offen offset:0 sc1
    buffer_load_dwordx2 v[42:43], v7, s[32:35], s44 offen offset:512 sc1
    s_waitcnt vmcnt(1)
    buffer_load_dwordx2 v[44:45], v7, s[32:35], s44 offen offset:1024 sc1
    s_waitcnt vmcnt(1)
    buffer_load_dwordx2 v[46:47], v7, s[32:35], s44 offen offset:1536 sc1
    s_waitcnt vmcnt(1)
    buffer_load_dwordx2 v[48:49], v7, s[32:35], s44 offen offset:2048 sc1
    s_waitcnt vmcnt(1)
    buffer_load_dwordx2 v[50:51], v7, s[32:35], s44 offen offset:2560 sc1
    s_waitcnt vmcnt(1)
    buffer_load_dwordx2 v[52:53], v7, s[32:35], s44 offen offset:3072 sc1
    s_waitcnt vmcnt(1)
    buffer_load_dwordx2 v[54:55], v7, s[32:35], s44 offen offset:3584 sc1
    s_waitcnt vmcnt(1)
    buffer_load_dwordx2 v[56:57], v7, s[32:35], s45 offen offset:0 sc1
    s_waitcnt vmcnt(1)
    buffer_load_dwordx2 v[58:59], v7, s[32:35], s45 offen offset:512 sc1
    s_waitcnt vmcnt(1)
    buffer_load_dwordx2 v[60:61], v7, s[32:35], s45 offen offset:1024 sc1
    s_waitcnt vmcnt(1)
    buffer_load_dwordx2 v[62:63], v7, s[32:35], s45 offen offset:1536 sc1
    s_waitcnt vmcnt(1)
    buffer_load_dwordx2 v[64:65], v7, s[32:35], s45 offen offset:2048 sc1
    s_waitcnt vmcnt(1)
    buffer_load_dwordx2 v[66:67], v7, s[32:35], s45 offen offset:2560 sc1
    s_waitcnt vmcnt(1)
    buffer_load_dwordx2 v[68:69], v7, s[32:35], s45 offen offset:3072 sc1
    s_waitcnt vmcnt(1)
    buffer_load_dwordx2 v[70:71], v7, s[32:35], s45 offen offset:3584 sc1
    s_waitcnt vmcnt(1)
    buffer_load_dwordx2 v[72:73], v7, s[32:35], s46 offen offset:0 sc1
    s_waitcnt vmcnt(1)
    buffer_load_dwordx2 v[74:75], v7, s[32:35], s46 offen offset:512 sc1
    s_waitcnt vmcnt(1)
    buffer_load_dwordx2 v[76:77], v7, s[32:35], s47 offen offset:0 sc1
    s_waitcnt vmcnt(1)
    buffer_load_dwordx2 v[78:79], v7, s[32:35], s47 offen offset:512 sc1
    s_waitcnt vmcnt(1)
    buffer_load_dwordx2 v[80:81], v7, s[32:35], s47 offen offset:1024 sc1
    s_waitcnt vmcnt(1)
    buffer_load_dwordx2 v[82:83], v7, s[32:35], s47 offen offset:1536 sc1
    s_waitcnt vmcnt(1)
    buffer_load_dwordx2 v[84:85], v7, s[32:35], s47 offen offset:2048 sc1
    s_waitcnt vmcnt(1)
    buffer_load_dwordx2 v[86:87], v7, s[32:35], s47 offen offset:2560 sc1
    s_waitcnt vmcnt(1)
    buffer_load_dwordx2 v[88:89], v7, s[32:35], s47 offen offset:3072 sc1
    s_waitcnt vmcnt(1)
    buffer_load_dwordx2 v[90:91], v7, s[32:35], s47 offen offset:3584 sc1
    s_waitcnt vmcnt(1)
    buffer_load_dwordx2 v[92:93], v7, s[32:35], s48 offen offset:0 sc1
    s_waitcnt vmcnt(1)
    buffer_load_dwordx2 v[94:95], v7, s[32:35], s48 offen offset:512 sc1
    s_waitcnt vmcnt(1)
    buffer_load_dwordx2 v[96:97], v7, s[32:35], s48 offen offset:1024 sc1
    s_waitcnt vmcnt(1)
    buffer_load_dwordx2 v[98:99], v7, s[32:35], s48 offen offset:1536 sc1
    s_waitcnt vmcnt(1)
    buffer_load_dwordx2 v[100:101], v7, s[32:35], s48 offen offset:2048 sc1
    s_waitcnt vmcnt(1)
    buffer_load_dwordx2 v[102:103], v7, s[32:35], s48 offen offset:2560 sc1
    s_waitcnt vmcnt(1)
    buffer_load_dwordx2 v[104:105], v7, s[32:35], s48 offen offset:3072 sc1
    s_waitcnt vmcnt(1)
    buffer_load_dwordx2 v[106:107], v7, s[32:35], s48 offen offset:3584 sc1
    s_waitcnt vmcnt(1)
    buffer_load_dwordx2 v[108:109], v7, s[32:35], s49 offen offset:0 sc1
    s_waitcnt vmcnt(1)
    buffer_load_dwordx2 v[110:111], v7, s[32:35], s49 offen offset:512 sc1
    s_waitcnt vmcnt(1)
    buffer_load_dwordx2 v[112:113], v7, s[32:35], s50 offen offset:0 sc1
    s_waitcnt vmcnt(1)
    buffer_load_dwordx2 v[114:115], v7, s[32:35], s50 offen offset:512 sc1
    s_waitcnt vmcnt(1)
    buffer_load_dwordx2 v[116:117], v7, s[32:35], s50 offen offset:1024 sc1
    s_waitcnt vmcnt(1)
    buffer_load_dwordx2 v[118:119], v7, s[32:35], s50 offen offset:1536 sc1
    s_waitcnt vmcnt(1)
    buffer_load_dwordx2 v[120:121], v7, s[32:35], s50 offen offset:2048 sc1
    s_waitcnt vmcnt(1)
    buffer_load_dwordx2 v[122:123], v7, s[32:35], s50 offen offset:2560 sc1
    s_waitcnt vmcnt(1)
    buffer_load_dwordx2 v[124:125], v7, s[32:35], s50 offen offset:3072 sc1
    s_waitcnt vmcnt(1)
    buffer_load_dwordx2 v[126:127], v7, s[32:35], s50 offen offset:3584 sc1
    s_waitcnt vmcnt(1)
    buffer_load_dwordx2 v[128:129], v7, s[32:35], s51 offen offset:0 sc1
    s_waitcnt vmcnt(1)
    buffer_load_dwordx2 v[130:131], v7, s[32:35], s51 offen offset:512 sc1
    s_waitcnt vmcnt(1)
    buffer_load_dwordx2 v[132:133], v7, s[32:35], s51 offen offset:1024 sc1
    s_waitcnt vmcnt(1)
    buffer_load_dwordx2 v[134:135], v7, s[32:35], s51 offen offset:1536 sc1
    s_waitcnt vmcnt(1)
    buffer_load_dwordx2 v[136:137], v7, s[32:35], s51 offen offset:2048 sc1
    s_waitcnt vmcnt(1)
    buffer_load_dwordx2 v[138:139], v7, s[32:35], s51 offen offset:2560 sc1
    s_waitcnt vmcnt(1)
    buffer_load_dwordx2 v[140:141], v7, s[32:35], s51 offen offset:3072 sc1
    s_waitcnt vmcnt(1)
    buffer_load_dwordx2 v[142:143], v7, s[32:35], s51 offen offset:3584 sc1
    s_waitcnt vmcnt(1)
    buffer_load_dwordx2 v[144:145], v7, s[32:35], s52 offen offset:0 sc1
    s_waitcnt vmcnt(1)
    buffer_load_dwordx2 v[146:147], v7, s[32:35], s52 offen offset:512 sc1
    s_waitcnt vmcnt(0)
    v_min_u32 v160, v41, v43
    v_min3_u32 v160, v160, v45, v47
    v_min3_u32 v160, v160, v49, v51
    v_min3_u32 v160, v160, v53, v55
    v_min3_u32 v160, v160, v57, v59
    v_min3_u32 v160, v160, v61, v63
    v_min3_u32 v160, v160, v65, v67
    v_min3_u32 v160, v160, v69, v71
    v_min3_u32 v160, v160, v73, v75
    v_min3_u32 v160, v160, v77, v79
    v_min3_u32 v160, v160, v81, v83
    v_min3_u32 v160, v160, v85, v87
    v_min3_u32 v160, v160, v89, v91
    v_min3_u32 v160, v160, v93, v95
    v_min3_u32 v160, v160, v97, v99
    v_min3_u32 v160, v160, v101, v103
    v_min3_u32 v160, v160, v105, v107
    v_min3_u32 v160, v160, v109, v111
    v_min3_u32 v160, v160, v113, v115
    v_min3_u32 v160, v160, v117, v119
    v_min3_u32 v160, v160, v121, v123
    v_min3_u32 v160, v160, v125, v127
    v_min3_u32 v160, v160, v129, v131
    v_min3_u32 v160, v160, v133, v135
    v_min3_u32 v160, v160, v137, v139
    v_min3_u32 v160, v160, v141, v143
    v_min3_u32 v160, v160, v145, v147
    v_max_u32 v161, v41, v43
    v_max3_u32 v161, v161, v45, v47
    v_max3_u32 v161, v161, v49, v51
    v_max3_u32 v161, v161, v53, v55
    v_max3_u32 v161, v161, v57, v59
    v_max3_u32 v161, v161, v61, v63
    v_max3_u32 v161, v161, v65, v67
    v_max3_u32 v161, v161, v69, v71
    v_max3_u32 v161, v161, v73, v75
    v_max3_u32 v161, v161, v77, v79
    v_max3_u32 v161, v161, v81, v83
    v_max3_u32 v161, v161, v85, v87
    v_max3_u32 v161, v161, v89, v91
    v_max3_u32 v161, v161, v93, v95
    v_max3_u32 v161, v161, v97, v99
    v_max3_u32 v161, v161, v101, v103
    v_max3_u32 v161, v161, v105, v107
    v_max3_u32 v161, v161, v109, v111
    v_max3_u32 v161, v161, v113, v115
    v_max3_u32 v161, v161, v117, v119
    v_max3_u32 v161, v161, v121, v123
    v_max3_u32 v161, v161, v125, v127
    v_max3_u32 v161, v161, v129, v131
    v_max3_u32 v161, v161, v133, v135
    v_max3_u32 v161, v161, v137, v139
    v_max3_u32 v161, v161, v141, v143
    v_max3_u32 v161, v161, v145, v147
    v_cmp_ne_u32 s[30:31], s60, v160
    v_cmp_ne_u32 vcc, s60, v161
    s_or_b64 vcc, vcc, s[30:31]
    s_add_u32 s61, s61, 1
    s_cmp_gt_u32 s61, 200000
    s_cbranch_scc1 L_pd_215
    s_cbranch_vccz L_pd_215
    s_sleep 127
    s_branch L_gm_214
L_pd_215:
    v_add_f32 v40, v40, v76
    v_add_f32 v42, v42, v78
    v_add_f32 v44, v44, v80
    v_add_f32 v46, v46, v82
    v_add_f32 v48, v48, v84
    v_add_f32 v50, v50, v86
    v_add_f32 v52, v52, v88
    v_add_f32 v54, v54, v90
    v_add_f32 v56, v56, v92
    v_add_f32 v58, v58, v94
    v_add_f32 v60, v60, v96
    v_add_f32 v62, v62, v98
    v_add_f32 v64, v64, v100
    v_add_f32 v66, v66, v102
    v_add_f32 v68, v68, v104
    v_add_f32 v70, v70, v106
    v_add_f32 v72, v72, v108
    v_add_f32 v74, v74, v110
    v_add_f32 v40, v40, v112
    v_add_f32 v42, v42, v114
    v_add_f32 v44, v44, v116
    v_add_f32 v46, v46, v118
    v_add_f32 v48, v48, v120
    v_add_f32 v50, v50, v122
    v_add_f32 v52, v52, v124
    v_add_f32 v54, v54, v126
    v_add_f32 v56, v56, v128
    v_add_f32 v58, v58, v130
    v_add_f32 v60, v60, v132
    v_add_f32 v62, v62, v134
    v_add_f32 v64, v64, v136
    v_add_f32 v66, v66, v138
    v_add_f32 v68, v68, v140
    v_add_f32 v70, v70, v142
    v_add_f32 v72, v72, v144
    v_add_f32 v74, v74, v146
    v_cvt_pk_bf16_f32 v112, 0, v40
    v_cvt_pk_bf16_f32 v122, 0, v58
    v_cvt_pk_bf16_f32 v113, 0, v42
    v_cvt_pk_bf16_f32 v123, 0, v60
    v_cvt_pk_bf16_f32 v114, 0, v44
    v_cvt_pk_bf16_f32 v124, 0, v62
    v_cvt_pk_bf16_f32 v115, 0, v46
    v_cvt_pk_bf16_f32 v125, 0, v64
    v_cvt_pk_bf16_f32 v116, 0, v48
    v_cvt_pk_bf16_f32 v126, 0, v66
    v_cvt_pk_bf16_f32 v117, 0, v50
    v_cvt_pk_bf16_f32 v127, 0, v68
    v_cvt_pk_bf16_f32 v118, 0, v52
    v_cvt_pk_bf16_f32 v128, 0, v70
    v_cvt_pk_bf16_f32 v119, 0, v54
    v_cvt_pk_bf16_f32 v129, 0, v72
    v_cvt_pk_bf16_f32 v120, 0, v56
    v_cvt_pk_bf16_f32 v130, 0, v74
    v_add_f32 v122, 1.0, v122
    v_add_f32 v123, 1.0, v123
    v_add_f32 v124, 1.0, v124
    v_add_f32 v125, 1.0, v125
    v_add_f32 v126, 1.0, v126
    v_add_f32 v127, 1.0, v127
    v_add_f32 v128, 1.0, v128
    v_add_f32 v129, 1.0, v129
    v_add_f32 v130, 1.0, v130
    v_cvt_pk_bf16_f32 v122, 0, v122
    v_cvt_pk_bf16_f32 v123, 0, v123
    v_cvt_pk_bf16_f32 v124, 0, v124
    v_cvt_pk_bf16_f32 v125, 0, v125
    v_cvt_pk_bf16_f32 v126, 0, v126
    v_cvt_pk_bf16_f32 v127, 0, v127
    v_cvt_pk_bf16_f32 v128, 0, v128
    v_cvt_pk_bf16_f32 v129, 0, v129
    v_cvt_pk_bf16_f32 v130, 0, v130
    v_and_b32 v6, 35, v0
    v_bfe_u32 v160, v0, 2, 2
    v_lshl_add_u32 v6, v160, 3, v6
    v_bfe_u32 v160, v0, 4, 1
    v_lshl_add_u32 v6, v160, 2, v6
    v_lshlrev_b32 v6, 1, v6
    v_lshlrev_b32 v7, 2, v0
    s_mul_i32 s48, s97, 2304
    s_add_u32 s48, s48, 229376
    s_mov_b32 s85, 2
    s_mov_b32 s87, 1
    s_mov_b32 s86, 200000
    s_mov_b32 s34, 0
    s_setprio 0
L_ffg_t:
    s_mov_b32 s61, s86
    s_waitcnt vmcnt(0)
    s_cmp_eq_u32 s87, 1
    s_cbranch_scc1 L_nb_216
    s_barrier
L_nb_216:
    buffer_load_dword v176, v7, s[32:35], s48 offen offset:0 sc1
    buffer_load_dword v177, v7, s[32:35], s48 offen offset:256 sc1
    buffer_load_dword v178, v7, s[32:35], s48 offen offset:512 sc1
    buffer_load_dword v179, v7, s[32:35], s48 offen offset:768 sc1
    buffer_load_dword v180, v7, s[32:35], s48 offen offset:1024 sc1
    buffer_load_dword v181, v7, s[32:35], s48 offen offset:1280 sc1
    buffer_load_dword v182, v7, s[32:35], s48 offen offset:1536 sc1
    buffer_load_dword v183, v7, s[32:35], s48 offen offset:1792 sc1
    buffer_load_dword v184, v7, s[32:35], s48 offen offset:2048 sc1
    s_cmp_eq_u32 s87, 1
    s_cbranch_scc1 L_nb_217
    s_barrier
L_nb_217:
    s_cbranch_scc1 L_nb_218
    s_barrier
L_nb_218:
    s_cmp_eq_u32 s87, 1
    s_cbranch_scc1 L_nb_219
    s_barrier
L_nb_219:
    ds_read_b64_tr_b16 v[40:41], v20 offset:0
    ds_read_b64_tr_b16 v[42:43], v20 offset:2048
    ds_read_b64_tr_b16 v[44:45], v20 offset:4096
    ds_read_b64_tr_b16 v[46:47], v20 offset:6144
    ds_read_b64_tr_b16 v[48:49], v20 offset:8192
    ds_read_b64_tr_b16 v[50:51], v20 offset:10240
    ds_read_b64_tr_b16 v[52:53], v20 offset:12288
    ds_read_b64_tr_b16 v[54:55], v20 offset:14336
    ds_read_b64_tr_b16 v[56:57], v20 offset:16384
    ds_read_b64_tr_b16 v[58:59], v20 offset:18432
    ds_read_b64_tr_b16 v[60:61], v20 offset:20480
    ds_read_b64_tr_b16 v[62:63], v20 offset:22528
    ds_read_b64_tr_b16 v[64:65], v20 offset:24576
    ds_read_b64_tr_b16 v[66:67], v20 offset:26624
    ds_read_b64_tr_b16 v[68:69], v20 offset:28672
    ds_read_b64_tr_b16 v[70:71], v20 offset:30720
    ds_read_b64_tr_b16 v[72:73], v20 offset:32768
    ds_read_b64_tr_b16 v[74:75], v20 offset:34816
    ds_read_b64_tr_b16 v[76:77], v21 offset:0
    ds_read_b64_tr_b16 v[78:79], v21 offset:2048
    ds_read_b64_tr_b16 v[80:81], v21 offset:4096
    ds_read_b64_tr_b16 v[82:83], v21 offset:6144
    ds_read_b64_tr_b16 v[84:85], v21 offset:8192
    ds_read_b64_tr_b16 v[86:87], v21 offset:10240
    ds_read_b64_tr_b16 v[88:89], v21 offset:12288
    ds_read_b64_tr_b16 v[90:91], v21 offset:14336
    ds_read_b64_tr_b16 v[92:93], v21 offset:16384
    ds_read_b64_tr_b16 v[94:95], v21 offset:18432
    ds_read_b64_tr_b16 v[96:97], v21 offset:20480
    ds_read_b64_tr_b16 v[98:99], v21 offset:22528
    ds_read_b64_tr_b16 v[100:101], v21 offset:24576
    ds_read_b64_tr_b16 v[102:103], v21 offset:26624
    ds_read_b64_tr_b16 v[104:105], v21 offset:28672
    ds_read_b64_tr_b16 v[106:107], v21 offset:30720
    ds_read_b64_tr_b16 v[108:109], v21 offset:32768
    ds_read_b64_tr_b16 v[110:111], v21 offset:34816
L_xp:
    buffer_load_dword v176, v7, s[32:35], s48 offen offset:0 sc1
    buffer_load_dword v177, v7, s[32:35], s48 offen offset:256 sc1
    buffer_load_dword v178, v7, s[32:35], s48 offen offset:512 sc1
    buffer_load_dword v179, v7, s[32:35], s48 offen offset:768 sc1
    buffer_load_dword v180, v7, s[32:35], s48 offen offset:1024 sc1
    buffer_load_dword v181, v7, s[32:35], s48 offen offset:1280 sc1
    buffer_load_dword v182, v7, s[32:35], s48 offen offset:1536 sc1
    buffer_load_dword v183, v7, s[32:35], s48 offen offset:1792 sc1
    buffer_load_dword v184, v7, s[32:35], s48 offen offset:2048 sc1
    s_waitcnt vmcnt(0)
    v_xor_b32 v176, s89, v176
    v_xor_b32 v177, s89, v177
    v_xor_b32 v178, s89, v178
    v_xor_b32 v179, s89, v179
    v_xor_b32 v180, s89, v180
    v_xor_b32 v181, s89, v181
    v_xor_b32 v182, s89, v182
    v_xor_b32 v183, s89, v183
    v_xor_b32 v184, s89, v184
    v_or3_b32 v160, v176, v177, v178
    v_or3_b32 v160, v160, v179, v180
    v_or3_b32 v160, v160, v181, v182
    v_or3_b32 v160, v160, v183, v184
    v_and_b32 v160, 65535, v160
    v_cmp_ne_u32 vcc, 0, v160
    s_add_u32 s61, s61, 1
    s_cmp_gt_u32 s61, 200000
    s_cbranch_scc1 L_pd_220
    s_cbranch_vccnz L_xp
L_pd_220:
    s_cmp_eq_u32 s87, 1
    s_cbranch_scc1 L_nb_221
    s_barrier
L_nb_221:
    v_readfirstlane_b32 s30, v176
    s_nop 1
    v_pk_add_f32 v[164:165], v[176:177], s[30:31] op_sel_hi:[1,0] neg_lo:[0,1] neg_hi:[0,1]
    v_pk_add_f32 v[166:167], v[178:179], s[30:31] op_sel_hi:[1,0] neg_lo:[0,1] neg_hi:[0,1]
    v_pk_add_f32 v[168:169], v[180:181], s[30:31] op_sel_hi:[1,0] neg_lo:[0,1] neg_hi:[0,1]
    v_pk_add_f32 v[170:171], v[182:183], s[30:31] op_sel_hi:[1,0] neg_lo:[0,1] neg_hi:[0,1]
    v_subrev_f32 v172, s30, v184
    v_pk_add_f32 v[160:161], v[164:165], v[166:167]
    v_pk_mul_f32 v[162:163], v[164:165], v[164:165]
    v_pk_fma_f32 v[162:163], v[166:167], v[166:167], v[162:163]
    v_pk_add_f32 v[160:161], v[160:161], v[168:169]
    v_pk_fma_f32 v[162:163], v[168:169], v[168:169], v[162:163]
    v_pk_add_f32 v[160:161], v[160:161], v[170:171]
    v_pk_fma_f32 v[162:163], v[170:171], v[170:171], v[162:163]
    v_add_f32 v160, v160, v172
    v_fmac_f32 v163, v172, v172
    v_add_f32 v160, v160, v161
    v_add_f32 v163, v163, v162
    s_nop 0
    v_add_f32_dpp v160, v160, v160 quad_perm:[1,0,3,2] row_mask:0xf bank_mask:0xf
    v_add_f32_dpp v163, v163, v163 quad_perm:[1,0,3,2] row_mask:0xf bank_mask:0xf
    s_nop 0
    v_add_f32_dpp v160, v160, v160 quad_perm:[2,3,0,1] row_mask:0xf bank_mask:0xf
    v_add_f32_dpp v163, v163, v163 quad_perm:[2,3,0,1] row_mask:0xf bank_mask:0xf
    s_nop 0
    v_add_f32_dpp v160, v160, v160 row_half_mirror row_mask:0xf bank_mask:0xf
    v_add_f32_dpp v163, v163, v163 row_half_mirror row_mask:0xf bank_mask:0xf
    s_nop 0
    v_add_f32_dpp v160, v160, v160 row_mirror row_mask:0xf bank_mask:0xf
    v_add_f32_dpp v163, v163, v163 row_mirror row_mask:0xf bank_mask:0xf
    s_nop 1
    v_permlane16_swap_b32 v160, v163
    v_add_f32 v160, v160, v163
    s_nop 0
    v_readlane_b32 s44, v160, 0
    v_readlane_b32 s45, v160, 16
    v_readlane_b32 s46, v160, 32
    v_readlane_b32 s47, v160, 48
    v_mov_b32 v162, s44
    v_mov_b32 v163, s45
    v_add_f32 v162, s46, v162
    v_add_f32 v163, s47, v163
    v_mul_f32 v162, 987991609, v162
    v_mul_f32 v163, 987991609, v163
    v_fma_f32 v160, -v162, v162, v163
    v_add_f32 v162, s30, v162
    v_max_f32 v160, 0, v160
    v_cvt_pk_bf16_f32 v162, 0, v162
    v_cvt_pk_bf16_f32 v160, 0, v160
    v_add_f32 v160, 925353388, v160
    v_cvt_pk_bf16_f32 v160, 0, v160
    v_sqrt_f32 v160, v160
    s_nop 0
    v_cvt_pk_bf16_f32 v160, 0, v160
    v_rcp_f32 v160, v160
    v_pk_add_f32 v[176:177], v[176:177], v[162:163] op_sel_hi:[1,0] neg_lo:[0,1] neg_hi:[0,1]
    v_pk_add_f32 v[178:179], v[178:179], v[162:163] op_sel_hi:[1,0] neg_lo:[0,1] neg_hi:[0,1]
    v_pk_add_f32 v[180:181], v[180:181], v[162:163] op_sel_hi:[1,0] neg_lo:[0,1] neg_hi:[0,1]
    v_pk_add_f32 v[182:183], v[182:183], v[162:163] op_sel_hi:[1,0] neg_lo:[0,1] neg_hi:[0,1]
    v_sub_f32 v184, v184, v162
    v_pk_mul_f32 v[176:177], v[176:177], v[122:123]
    v_pk_mul_f32 v[178:179], v[178:179], v[124:125]
    v_pk_mul_f32 v[180:181], v[180:181], v[126:127]
    v_pk_mul_f32 v[182:183], v[182:183], v[128:129]
    v_mul_f32 v184, v184, v130
    v_pk_fma_f32 v[176:177], v[176:177], v[160:161], v[112:113] op_sel_hi:[1,0,1]
    v_pk_fma_f32 v[178:179], v[178:179], v[160:161], v[114:115] op_sel_hi:[1,0,1]
    v_pk_fma_f32 v[180:181], v[180:181], v[160:161], v[116:117] op_sel_hi:[1,0,1]
    v_pk_fma_f32 v[182:183], v[182:183], v[160:161], v[118:119] op_sel_hi:[1,0,1]
    v_fma_f32 v184, v184, v160, v120
    v_cvt_pk_bf16_f32 v176, v176, v177
    ds_write_b16 v6, v176 offset:512
    ds_write_b16_d16_hi v6, v176 offset:640
    v_cvt_pk_bf16_f32 v178, v178, v179
    ds_write_b16 v6, v178 offset:768
    ds_write_b16_d16_hi v6, v178 offset:896
    v_cvt_pk_bf16_f32 v180, v180, v181
    ds_write_b16 v6, v180 offset:1024
    ds_write_b16_d16_hi v6, v180 offset:1152
    v_cvt_pk_bf16_f32 v182, v182, v183
    ds_write_b16 v6, v182 offset:1280
    ds_write_b16_d16_hi v6, v182 offset:1408
    v_cvt_pk_bf16_f32 v184, v184, v184
    ds_write_b16 v6, v184 offset:1536
    s_waitcnt lgkmcnt(0)
    s_cmp_eq_u32 s87, 1
    s_cbranch_scc1 L_nb_222
    s_barrier
L_nb_222:
    ds_read_b128 v[220:223], v3 offset:512
    ds_read_b128 v[224:227], v3 offset:576
    ds_read_b128 v[228:231], v3 offset:640
    ds_read_b128 v[232:235], v3 offset:704
    ds_read_b128 v[236:239], v3 offset:768
    ds_read_b128 v[240:243], v3 offset:832
    ds_read_b128 v[244:247], v3 offset:896
    ds_read_b128 v[248:251], v3 offset:960
    ds_read_b128 v[252:255], v3 offset:1024
    s_waitcnt lgkmcnt(8)
    v_mfma_f32_16x16x32_bf16 v[208:211], v[40:43], v[220:223], 0
    ds_read_b128 v[220:223], v3 offset:1088
    s_waitcnt lgkmcnt(8)
    v_mfma_f32_16x16x32_bf16 v[208:211], v[44:47], v[224:227], v[208:211]
    ds_read_b128 v[224:227], v3 offset:1152
    s_waitcnt lgkmcnt(8)
    v_mfma_f32_16x16x32_bf16 v[208:211], v[48:51], v[228:231], v[208:211]
    ds_read_b128 v[228:231], v3 offset:1216
    s_waitcnt lgkmcnt(8)
    v_mfma_f32_16x16x32_bf16 v[208:211], v[52:55], v[232:235], v[208:211]
    ds_read_b128 v[232:235], v3 offset:1280
    s_waitcnt lgkmcnt(8)
    v_mfma_f32_16x16x32_bf16 v[208:211], v[56:59], v[236:239], v[208:211]
    ds_read_b128 v[236:239], v3 offset:1344
    s_waitcnt lgkmcnt(8)
    v_mfma_f32_16x16x32_bf16 v[208:211], v[60:63], v[240:243], v[208:211]
    ds_read_b128 v[240:243], v3 offset:1408
    s_waitcnt lgkmcnt(8)
    v_mfma_f32_16x16x32_bf16 v[208:211], v[64:67], v[244:247], v[208:211]
    ds_read_b128 v[244:247], v3 offset:1472
    s_waitcnt lgkmcnt(8)
    v_mfma_f32_16x16x32_bf16 v[208:211], v[68:71], v[248:251], v[208:211]
    ds_read_b128 v[248:251], v3 offset:1536
    s_waitcnt lgkmcnt(8)
    v_mfma_f32_16x16x32_bf16 v[208:211], v[72:75], v[252:255], v[208:211]
    ds_read_b128 v[252:255], v3 offset:1600
    s_waitcnt lgkmcnt(8)
    v_mfma_f32_16x16x32_bf16 v[208:211], v[76:79], v[220:223], v[208:211]
    s_waitcnt lgkmcnt(7)
    v_mfma_f32_16x16x32_bf16 v[208:211], v[80:83], v[224:227], v[208:211]
    s_waitcnt lgkmcnt(6)
    v_mfma_f32_16x16x32_bf16 v[208:211], v[84:87], v[228:231], v[208:211]
    s_waitcnt lgkmcnt(5)
    v_mfma_f32_16x16x32_bf16 v[208:211], v[88:91], v[232:235], v[208:211]
    s_waitcnt lgkmcnt(4)
    v_mfma_f32_16x16x32_bf16 v[208:211], v[92:95], v[236:239], v[208:211]
    s_waitcnt lgkmcnt(3)
    v_mfma_f32_16x16x32_bf16 v[208:211], v[96:99], v[240:243], v[208:211]
    s_waitcnt lgkmcnt(2)
    v_mfma_f32_16x16x32_bf16 v[208:211], v[100:103], v[244:247], v[208:211]
    s_waitcnt lgkmcnt(1)
    v_mfma_f32_16x16x32_bf16 v[208:211], v[104:107], v[248:251], v[208:211]
    s_waitcnt lgkmcnt(0)
    v_mfma_f32_16x16x32_bf16 v[208:211], v[108:111], v[252:255], v[208:211]
    s_nop 7
    v_max_f32 v208, 0, v208
    v_max_f32 v209, 0, v209
    v_max_f32 v210, 0, v210
    v_max_f32 v211, 0, v211
    v_cvt_pk_bf16_f32 v212, v208, v209
    v_cvt_pk_bf16_f32 v213, v210, v211
    s_mov_b32 exec_lo, 0x00010001
    s_mov_b32 exec_hi, 0x00010001
    ds_write_b64 v22, v[212:213] offset:6272
    s_mov_b64 exec, -1
    s_waitcnt lgkmcnt(0)
    s_cmp_eq_u32 s87, 1
    s_cbranch_scc1 L_nb_223
    s_barrier
L_nb_223:
    s_branch L_tend
L_l2p:
    s_cmp_eq_u32 s87, 1
    s_cbranch_scc1 L_tend
    s_cmp_lt_u32 s98, 0
    s_cbranch_scc1 L_wend
    s_mov_b32 s40, s16
    s_mov_b32 s41, s17
    s_mov_b32 s42, 5308416
    s_mov_b32 s43, 0x20000
    v_min_u32 v3, 26, v0
    v_mul_u32_u24 v4, 7282, v3
    v_lshrrev_b32 v4, 16, v4
    v_mul_u32_u24 v5, 9, v4
    v_sub_u32 v3, v3, v5
    v_mul_u32_u24 v4, 1769472, v4
    v_mul_u32_u24 v3, 128, v3
    v_add_u32 v3, v3, v4
    s_mul_i32 s50, s97, 1152
    s_add_u32 s51, s98, 48
    s_min_u32 s49, s51, 191
    s_mul_i32 s49, s49, 9216
    s_add_u32 s49, s49, s50
    buffer_load_dword v6, v3, s[40:43], s49 offen
    s_add_u32 s51, s51, 14
    s_min_u32 s49, s51, 191
    s_mul_i32 s49, s49, 9216
    s_add_u32 s49, s49, s50
    buffer_load_dword v6, v3, s[40:43], s49 offen
    s_add_u32 s51, s51, 14
    s_min_u32 s49, s51, 191
    s_mul_i32 s49, s49, 9216
    s_add_u32 s49, s49, s50
    buffer_load_dword v6, v3, s[40:43], s49 offen
    s_add_u32 s51, s51, 14
    s_min_u32 s49, s51, 191
    s_mul_i32 s49, s49, 9216
    s_add_u32 s49, s49, s50
    buffer_load_dword v6, v3, s[40:43], s49 offen
    s_add_u32 s51, s51, 14
    s_min_u32 s49, s51, 191
    s_mul_i32 s49, s49, 9216
    s_add_u32 s49, s49, s50
    buffer_load_dword v6, v3, s[40:43], s49 offen
    s_add_u32 s51, s51, 14
    s_min_u32 s49, s51, 191
    s_mul_i32 s49, s49, 9216
    s_add_u32 s49, s49, s50
    buffer_load_dword v6, v3, s[40:43], s49 offen
    s_add_u32 s51, s51, 14
    s_min_u32 s49, s51, 191
    s_mul_i32 s49, s49, 9216
    s_add_u32 s49, s49, s50
    buffer_load_dword v6, v3, s[40:43], s49 offen
    s_add_u32 s51, s51, 14
    s_min_u32 s49, s51, 191
    s_mul_i32 s49, s49, 9216
    s_add_u32 s49, s49, s50
    buffer_load_dword v6, v3, s[40:43], s49 offen
    s_add_u32 s51, s51, 14
    s_min_u32 s49, s51, 191
    s_mul_i32 s49, s49, 9216
    s_add_u32 s49, s49, s50
    buffer_load_dword v6, v3, s[40:43], s49 offen
    s_add_u32 s51, s51, 14
    s_min_u32 s49, s51, 191
    s_mul_i32 s49, s49, 9216
    s_add_u32 s49, s49, s50
    buffer_load_dword v6, v3, s[40:43], s49 offen
    s_add_u32 s51, s51, 14
    s_min_u32 s49, s51, 191
    s_mul_i32 s49, s49, 9216
    s_add_u32 s49, s49, s50
    buffer_load_dword v6, v3, s[40:43], s49 offen
    s_add_u32 s51, s51, 14
    s_mov_b32 s36, s18
    s_mov_b32 s37, s19
    s_mov_b32 s38, 5308416
    s_mov_b32 s39, 0x20000
    v_lshlrev_b32 v2, 4, v0
    s_mul_i32 s48, s97, 663552
    s_sub_u32 s49, s98, 0
    s_lshl_b32 s49, s49, 10
    s_add_u32 s48, s48, s49
    v_min_u32 v3, 41, v0
    v_mul_u32_u24 v4, 1561, v3
    v_lshrrev_b32 v4, 16, v4
    v_mul_u32_u24 v5, 42, v4
    v_sub_u32 v3, v3, v5
    s_sub_u32 s49, s98, 0
    s_mul_i32 s49, s49, 42
    v_add_u32 v3, s49, v3
    v_mul_u32_u24 v3, 128, v3
    v_min_u32 v3, 73724, v3
    v_mul_u32_u24 v4, 73728, v4
    v_add_u32 v3, v3, v4
    s_mul_i32 s49, s97, 663552
    s_add_u32 s49, s49, 0
    buffer_load_dword v6, v3, s[36:39], s49 offen
    s_mul_i32 s49, s97, 663552
    s_add_u32 s49, s49, 73728
    buffer_load_dword v6, v3, s[36:39], s49 offen
    s_mul_i32 s49, s97, 663552
    s_add_u32 s49, s49, 147456
    buffer_load_dword v6, v3, s[36:39], s49 offen
    s_mul_i32 s49, s97, 663552
    s_add_u32 s49, s49, 221184
    buffer_load_dword v6, v3, s[36:39], s49 offen
    s_mul_i32 s49, s97, 663552
    s_add_u32 s49, s49, 294912
    buffer_load_dword v6, v3, s[36:39], s49 offen
    s_mul_i32 s49, s97, 663552
    s_add_u32 s49, s49, 368640
    buffer_load_dword v6, v3, s[36:39], s49 offen
    s_mul_i32 s49, s97, 663552
    s_add_u32 s49, s49, 442368
    buffer_load_dword v6, v3, s[36:39], s49 offen
    s_mul_i32 s49, s97, 663552
    s_add_u32 s49, s49, 516096
    buffer_load_dword v6, v3, s[36:39], s49 offen
    s_mul_i32 s49, s97, 663552
    s_add_u32 s49, s49, 589824
    buffer_load_dword v6, v3, s[36:39], s49 offen
    s_branch L_wend
L_tend:
    s_cmp_eq_u32 s87, 0
    s_cbranch_scc1 L_wend
    s_waitcnt vmcnt(0) lgkmcnt(0)
    s_mov_b32 s87, 0
    s_mov_b32 s86, 0
    s_mov_b32 s34, 2097152
    s_setprio 3
    s_cmp_eq_u32 s85, 0
    s_cbranch_scc1 L_sync
    s_branch L_ffg_t
L_end:
    s_endpgm
.section .rodata,"a"
.p2align 6
.amdhsa_kernel adaLN_cond__gqa_block_cached__dense_activation_relu__decode_kernel
.amdhsa_next_free_vgpr 256
.amdhsa_next_free_sgpr 102
.amdhsa_accum_offset 256
.amdhsa_group_segment_fixed_size 0
.amdhsa_kernarg_size 104
.amdhsa_user_sgpr_count 2
.amdhsa_user_sgpr_kernarg_segment_ptr 1
.amdhsa_system_sgpr_workgroup_id_x 1
.amdhsa_float_denorm_mode_32 3
.end_amdhsa_kernel
```
